```python
import torch

def _softmax(x, axis=-1):
    return torch.softmax(x, dim=axis)

def _gelu(x):
    return torch.nn.functional.gelu(x, approximate='tanh')

def _silu(x):
    return torch.nn.functional.silu(x)

def _sigmoid(x):
    return torch.sigmoid(x)

def _layernorm(x, axis=-1, eps=1e-05):
    m = x.mean(dim=axis, keepdim=True)
    v = x.var(dim=axis, keepdim=True, unbiased=False)
    return (x - m) / torch.sqrt(v + eps)

def _scatter_add(tgt, idx, src, axis=0):
    return tgt.clone().index_add_(axis, idx, src)

def _segment_sum(src, seg, n):
    out = torch.zeros((n,) + src.shape[1:], dtype=src.dtype)
    return out.index_add_(0, seg, src)

def _pad(x, pw):
    flat = tuple((v for pair in reversed(pw) for v in pair))
    return torch.nn.functional.pad(x, flat)
kernel_name = 'gather_scatter__tensor_product_equiv_equiformer__graph'

def setup_inputs():

    _w = lambda a: (lambda t: t.to(torch.bfloat16) if t.is_floating_point() else t)(torch.as_tensor(a))
    N, deg, C, De = (10000, 64, 64, max(4, 1))
    E = N * deg
    src = (lambda lo, hi, *s: torch.randint(lo, hi, s))(0, N, E).to(torch.int64)
    dst = (lambda lo, hi, *s: torch.randint(lo, hi, s))(0, N, E).to(torch.int64)
    rvec = (lambda *s: torch.randn(*s, dtype=torch.bfloat16) * 0.05)(E, 3).to(float)
    rn = (torch.linalg.norm(rvec, dim=-1, keepdim=True) + 1e-06).to(float)
    rhat = (rvec / rn).to(float)
    eps = torch.zeros((3, 3, 3), dtype=float)
    eps[0, 1, 2] = eps[1, 2, 0] = eps[2, 0, 1] = 1.0
    eps[0, 2, 1] = eps[2, 1, 0] = eps[1, 0, 2] = -1.0
    return {'x': _w((lambda *s: torch.randn(*s, dtype=torch.bfloat16) * 0.4)(N, 4 * C).to(float)), 'rhat': _w(rhat), 'e_attr': _w((lambda *s: torch.randn(*s, dtype=torch.bfloat16) * 0.4)(E, De).to(float)), 'src': _w(src), 'dst': _w(dst), 'w_rad': _w((lambda *s: torch.randn(*s, dtype=torch.bfloat16) * 0.4)(De, 5 * C).to(float)), 'w_si0': _w((lambda *s: torch.randn(*s, dtype=torch.bfloat16) * 0.4)(2 * C, C).to(float)), 'w_si1': _w((lambda *s: torch.randn(*s, dtype=torch.bfloat16) * 0.05)(3 * C, C).to(float)), 'cg_eps': _w(eps)}

def reference(x, rhat, e_attr, src, dst, w_rad, w_si0, w_si1, cg_eps):
    N = x.shape[0]
    C = w_si0.shape[1]
    E = rhat.shape[0]
    x0 = x[:, :C].clone()
    x1 = x[:, C:].reshape(N, 3, C)
    R = (e_attr @ w_rad).reshape(E, 5, C)
    f0 = x0[src]
    f1 = x1[src]
    Y1 = rhat
    p00_0 = f0 * R[:, 0, :]
    p11_0 = torch.einsum('ejc,ej->ec', f1, Y1) * R[:, 1, :]
    p01_1 = torch.einsum('ec,ej->ejc', f0, Y1) * R[:, 2, :][:, None, :]
    p10_1 = f1 * R[:, 3, :][:, None, :]
    p11_1 = torch.einsum('ijk,ekc,ej->eic', cg_eps, f1, Y1) * R[:, 4, :][:, None, :]
    m0 = torch.concatenate([p00_0, p11_0], axis=-1) @ w_si0
    m1 = torch.einsum('ejp,pc->ejc', torch.concatenate([p01_1, p10_1, p11_1], axis=-1), w_si1)
    agg0 = _segment_sum(m0, dst, N)
    agg1 = _segment_sum(m1.reshape(E, 3 * C), dst, N).reshape(N, 3, C)
    gate = _sigmoid(agg0)
    out1 = agg1 * gate[:, None, :]
    return torch.concatenate([agg0, out1.reshape(N, 3 * C)], axis=-1)
```

```asm
; @launch kernel=part_kernel grid=(256,1,1) block=(640,1,1) lds=55296
; @launch kernel=main_kernel grid=(256,1,1) block=(512,1,1) lds=152576
.amdgcn_target "amdgcn-amd-amdhsa--gfx950"
.text
.globl part_kernel
.p2align 8
.type part_kernel,@function
part_kernel:
s_cmp_ge_u32 s2, 256
s_cbranch_scc1 part_kernel_done
s_load_dwordx4 s[4:7], s[0:1], 8
s_load_dwordx4 s[8:11], s[0:1], 24
s_load_dwordx2 s[12:13], s[0:1], 88
s_getpc_b64 s[72:73]
part_kernel_pc0:
v_lshlrev_b32 v69, 6, v0
s_mov_b32 s57, part_kernel_done-part_kernel_pc0
v_mov_b32 v71, s73
v_cmp_gt_u32 s[58:59], s57, v69
v_add_co_u32 v70, s[52:53], s72, v69
s_nop 1
v_addc_co_u32 v71, s[52:53], 0, v71, s[52:53]
s_mov_b64 exec, s[58:59]
s_cbranch_execz part_kernel_noself
global_load_dword v72, v[70:71], off
part_kernel_noself:
s_mov_b64 exec, -1
v_lshlrev_b32 v1, 2, v0
v_mov_b32 v2, 0
ds_write_b32 v1, v2
v_lshlrev_b32 v3, 4, v0
v_lshlrev_b32 v4, 5, v0
v_mul_u32_u24 v5, 24, v0
s_mul_i32 s14, s2, 10000
s_mul_i32 s15, s2, 20000
s_mul_i32 s16, s2, 15000
s_mul_i32 s17, s2, 2500
s_mul_i32 s18, s2, 40000
v_cmp_gt_u32 vcc, 625, v0
s_waitcnt lgkmcnt(0)
s_mov_b32 s20, s10
s_and_b32 s21, s11, 0xffff
s_mov_b32 s22, 2560000
s_mov_b32 s23, 0x20000
s_mov_b32 s24, s8
s_and_b32 s25, s9, 0xffff
s_mov_b32 s26, 2560000
s_mov_b32 s27, 0x20000
s_mov_b32 s28, s6
s_and_b32 s29, s7, 0xffff
s_mov_b32 s30, 5120000
s_mov_b32 s31, 0x20000
s_mov_b32 s32, s4
s_and_b32 s33, s5, 0xffff
s_mov_b32 s34, 3840000
s_mov_b32 s35, 0x20000
s_mov_b32 s36, s12
s_and_b32 s37, s13, 0xffff
s_mov_b32 s38, 13239296
s_mov_b32 s39, 0x20000
s_and_saveexec_b64 s[40:41], vcc
buffer_load_dwordx4 v[8:11], v3, s[20:23], s14 offen nt
buffer_load_dwordx4 v[12:15], v3, s[24:27], s14 offen nt
buffer_load_dwordx4 v[16:19], v4, s[28:31], s15 offen nt
buffer_load_dwordx4 v[20:23], v4, s[28:31], s15 offen offset:16 nt
buffer_load_dwordx4 v[24:27], v5, s[32:35], s16 offen nt
buffer_load_dwordx2 v[28:29], v5, s[32:35], s16 offen offset:16 nt
s_mov_b64 s[54:55], exec
s_mov_b64 exec, -1
s_lshr_b32 s56, s2, 3
v_and_b32 v68, 63, v0
s_getpc_b64 s[72:73]
part_kernel_pc:
s_add_u32 s72, s72, main_kernel-part_kernel_pc
s_addc_u32 s73, s73, 0
s_lshl_b32 s57, s56, 3
v_add_u32 v69, s57, v68
v_lshlrev_b32 v69, 6, v69
s_mov_b32 s57, main_kernel_done-main_kernel
v_cmp_gt_u32 s[58:59], s57, v69
v_cmp_gt_u32 s[52:53], 8, v0
s_and_b64 s[58:59], s[58:59], s[52:53]
v_mov_b32 v71, s73
v_add_co_u32 v70, s[52:53], s72, v69
s_nop 1
v_addc_co_u32 v71, s[52:53], 0, v71, s[52:53]
s_mov_b64 exec, s[58:59]
s_cbranch_execz part_kernel_nocode
global_load_dword v73, v[70:71], off
part_kernel_nocode:
s_mov_b64 exec, -1
s_load_dwordx4 s[72:75], s[0:1], 40
s_load_dwordx2 s[76:77], s[0:1], 56
v_subrev_u32 v70, 64, v0
s_mul_i32 s57, s56, 6
v_add_u32 v70, s57, v70
v_lshlrev_b32 v70, 7, v70
v_subrev_u32 v71, 64, v0
v_cmp_gt_u32 s[58:59], 6, v71
s_waitcnt lgkmcnt(0)
s_mov_b32 s48, s74
s_and_b32 s49, s75, 0xffff
s_mov_b32 s50, 16384
s_mov_b32 s51, 0x20000
s_mov_b32 s76, s76
s_and_b32 s77, s77, 0xffff
s_mov_b32 s78, 24576
s_mov_b32 s79, 0x20000
s_mov_b32 s72, s72
s_and_b32 s73, s73, 0xffff
s_mov_b32 s74, 2560
s_mov_b32 s75, 0x20000
s_mov_b64 exec, s[58:59]
s_cbranch_execz part_kernel_now
buffer_load_dword v74, v70, s[48:51], 0 offen
buffer_load_dword v75, v70, s[76:79], 0 offen
buffer_load_dword v76, v70, s[72:75], 0 offen
part_kernel_now:
s_mov_b64 exec, s[54:55]
s_mov_b32 s19, 429497
s_movk_i32 s42, 625
s_movk_i32 s43, 205
v_mov_b32 v2, 1
s_barrier
s_waitcnt vmcnt(5)
v_mul_u32_u24 v30, s19, v8
v_lshrrev_b32 v30, 24, v30
v_mul_u32_u24 v31, s19, v9
v_lshrrev_b32 v31, 24, v31
v_mul_u32_u24 v32, s19, v10
v_lshrrev_b32 v32, 24, v32
v_mul_u32_u24 v33, s19, v11
v_lshrrev_b32 v33, 24, v33
v_mad_u32_u24 v42, v30, s42, 15
v_lshrrev_b32 v42, 4, v42
v_sub_u32 v42, v8, v42
v_lshlrev_b32 v30, 2, v30
ds_add_rtn_u32 v38, v30, v2
v_mad_u32_u24 v43, v31, s42, 15
v_lshrrev_b32 v43, 4, v43
v_sub_u32 v43, v9, v43
v_lshlrev_b32 v31, 2, v31
ds_add_rtn_u32 v39, v31, v2
v_mad_u32_u24 v44, v32, s42, 15
v_lshrrev_b32 v44, 4, v44
v_sub_u32 v44, v10, v44
v_lshlrev_b32 v32, 2, v32
ds_add_rtn_u32 v40, v32, v2
v_mad_u32_u24 v45, v33, s42, 15
v_lshrrev_b32 v45, 4, v45
v_sub_u32 v45, v11, v45
v_lshlrev_b32 v33, 2, v33
ds_add_rtn_u32 v41, v33, v2
v_mov_b32 v34, v42
v_mov_b32 v35, v43
v_mov_b32 v36, v44
v_mov_b32 v37, v45
s_waitcnt lgkmcnt(0)
s_barrier
s_mov_b64 exec, -1
v_and_b32 v6, 63, v0
v_lshlrev_b32 v7, 4, v6
ds_read_b128 v[44:47], v7 offset:0
s_waitcnt lgkmcnt(0)
v_add_u32 v48, v44, v45
v_add_u32 v49, v48, v46
v_add_u32 v50, v49, v47
v_mov_b32 v51, v50
s_nop 1
v_add_u32_dpp v51, v51, v51 row_shr:1 row_mask:0xf bank_mask:0xf bound_ctrl:0
s_nop 1
v_add_u32_dpp v51, v51, v51 row_shr:2 row_mask:0xf bank_mask:0xf bound_ctrl:0
s_nop 1
v_add_u32_dpp v51, v51, v51 row_shr:4 row_mask:0xf bank_mask:0xf bound_ctrl:0
s_nop 1
v_add_u32_dpp v51, v51, v51 row_shr:8 row_mask:0xf bank_mask:0xf bound_ctrl:0
s_nop 1
v_add_u32_dpp v51, v51, v51 row_bcast:15 row_mask:0xa bank_mask:0xf
s_nop 1
v_add_u32_dpp v51, v51, v51 row_bcast:31 row_mask:0xc bank_mask:0xf
v_sub_u32 v52, v51, v50
v_add_u32 v53, v52, v44
v_add_u32 v54, v52, v48
v_add_u32 v55, v52, v49
ds_write_b128 v7, v[52:55] offset:2560
v_add_u32 v60, s17, v52
v_lshl_or_b32 v60, v44, 20, v60
v_add_u32 v61, s17, v53
v_lshl_or_b32 v61, v45, 20, v61
v_add_u32 v62, s17, v54
v_lshl_or_b32 v62, v46, 20, v62
v_add_u32 v63, s17, v55
v_lshl_or_b32 v63, v47, 20, v63
s_waitcnt lgkmcnt(0)
s_mov_b64 exec, s[40:41]
s_and_b64 exec, exec, vcc
ds_read_b32 v44, v30 offset:2560
ds_read_b32 v45, v31 offset:2560
ds_read_b32 v46, v32 offset:2560
ds_read_b32 v47, v33 offset:2560
s_waitcnt lgkmcnt(0)
v_lshl_add_u32 v48, v30, 3, v38
v_cmp_gt_u32 s[52:53], 32, v38
v_lshl_add_u32 v49, v31, 3, v39
v_cmp_gt_u32 s[54:55], 32, v39
v_lshl_add_u32 v50, v32, 3, v40
v_cmp_gt_u32 s[56:57], 32, v40
v_lshl_add_u32 v51, v33, 3, v41
v_cmp_gt_u32 s[58:59], 32, v41
v_add_u32 v38, v38, v44
ds_write_b8 v38, v34 offset:3584
v_add_u32 v39, v39, v45
ds_write_b8 v39, v35 offset:3584
v_add_u32 v40, v40, v46
ds_write_b8 v40, v36 offset:3584
v_add_u32 v41, v41, v47
ds_write_b8 v41, v37 offset:3584
s_mov_b64 s[50:51], exec
s_and_b64 exec, s[50:51], s[52:53]
ds_write_b8 v48, v34 offset:47104
s_and_b64 exec, s[50:51], s[54:55]
ds_write_b8 v49, v35 offset:47104
s_and_b64 exec, s[50:51], s[56:57]
ds_write_b8 v50, v36 offset:47104
s_and_b64 exec, s[50:51], s[58:59]
ds_write_b8 v51, v37 offset:47104
s_mov_b64 exec, s[50:51]
s_waitcnt vmcnt(0)
s_mov_b32 s44, 0x05040100
s_mov_b32 s45, 0x05040302
v_mov_b32 v44, v16
v_mov_b32 v45, v17
v_mov_b32 v48, v18
v_mov_b32 v49, v19
v_mov_b32 v52, v20
v_mov_b32 v53, v21
v_mov_b32 v56, v22
v_mov_b32 v57, v23
v_mov_b32 v46, v24
v_perm_b32 v47, v12, v25, s44
v_alignbit_b32 v50, v26, v25, 16
v_perm_b32 v51, v13, v26, s45
v_mov_b32 v54, v27
v_perm_b32 v55, v14, v28, s44
v_alignbit_b32 v58, v29, v28, 16
v_perm_b32 v59, v15, v29, s45
v_lshlrev_b32 v38, 4, v38
v_lshlrev_b32 v39, 4, v39
v_lshlrev_b32 v40, 4, v40
v_lshlrev_b32 v41, 4, v41
ds_write_b128 v38, v[44:47] offset:6144
ds_write_b128 v39, v[48:51] offset:6144
ds_write_b128 v40, v[52:55] offset:6144
ds_write_b128 v41, v[56:59] offset:6144
s_waitcnt lgkmcnt(0)
s_barrier
ds_read_b32 v7, v1 offset:3584
s_mov_b64 s[50:51], exec
s_mov_b64 exec, -1
ds_read_b128 v[64:67], v3 offset:47104
ds_read_b128 v[44:47], v3 offset:6144
ds_read_b128 v[48:51], v3 offset:16384
ds_read_b128 v[52:55], v3 offset:26624
ds_read_b128 v[56:59], v3 offset:36864
v_add_u32 v38, 30720, v3
v_cmp_gt_u32 vcc, 40000, v38
v_add_u32 v39, 0, v3
v_add_u32 v40, 10240, v3
v_add_u32 v41, 20480, v3
s_waitcnt lgkmcnt(3)
buffer_store_dwordx4 v[44:47], v39, s[36:39], s18 offen sc1
s_waitcnt lgkmcnt(2)
buffer_store_dwordx4 v[48:51], v40, s[36:39], s18 offen sc1
s_waitcnt lgkmcnt(1)
buffer_store_dwordx4 v[52:55], v41, s[36:39], s18 offen sc1
s_waitcnt lgkmcnt(0)
s_and_b64 exec, exec, vcc
s_cbranch_execz part_kernel_tail
buffer_store_dwordx4 v[56:59], v38, s[36:39], s18 offen sc1
part_kernel_tail:
s_mov_b64 exec, s[50:51]
s_waitcnt lgkmcnt(0)
s_add_u32 s46, s17, 10240000
buffer_store_dword v7, v1, s[36:39], s46 offen sc1
s_lshl_b32 s46, s2, 13
s_add_u32 s46, s46, 11142144
s_mov_b64 s[50:51], exec
v_cmp_gt_u32 vcc, 512, v0
s_and_b64 exec, exec, vcc
s_cbranch_execz part_kernel_no32
buffer_store_dwordx4 v[64:67], v3, s[36:39], s46 offen sc1
part_kernel_no32:
s_mov_b64 exec, s[50:51]
v_readfirstlane_b32 s47, v0
s_nop 3
s_cmp_ge_u32 s47, 64
s_cbranch_scc1 part_kernel_notab
s_lshl_b32 s46, s2, 10
s_add_u32 s46, s46, 10880000
v_lshlrev_b32 v6, 4, v6
buffer_store_dwordx4 v[60:63], v6, s[36:39], s46 offen sc1
part_kernel_notab:
part_kernel_done:
s_endpgm
.section .rodata,"a"
.p2align 6
.amdhsa_kernel part_kernel
  .amdhsa_next_free_vgpr 80
  .amdhsa_next_free_sgpr 80
  .amdhsa_accum_offset 80
  .amdhsa_group_segment_fixed_size 0
  .amdhsa_kernarg_size 96
  .amdhsa_user_sgpr_count 2
  .amdhsa_user_sgpr_kernarg_segment_ptr 1
  .amdhsa_system_sgpr_workgroup_id_x 1
.end_amdhsa_kernel
.text
.text
.globl main_kernel
.p2align 8
.type main_kernel,@function
main_kernel:
s_cmp_ge_u32 s2, 256
s_cbranch_scc1 main_kernel_done
s_load_dwordx2 s[4:5], s[0:1], 0
s_load_dwordx4 s[8:11], s[0:1], 40
s_load_dwordx2 s[12:13], s[0:1], 56
s_load_dwordx2 s[14:15], s[0:1], 72
s_load_dwordx2 s[6:7], s[0:1], 88
v_lshrrev_b32 v1, 6, v0
s_and_b32 s95, s2, 7
s_lshl_b32 s95, s95, 5
s_lshr_b32 s84, s2, 3
s_or_b32 s95, s95, s84
v_readfirstlane_b32 s3, v1
s_waitcnt lgkmcnt(0)
s_mov_b32 s20, s6
s_and_b32 s21, s7, 0xffff
s_mov_b32 s22, 29360128
s_mov_b32 s23, 0x20000
s_lshl_b32 s84, s3, 15
s_lshl_b32 s85, s95, 2
s_add_u32 s84, s84, s85
s_add_u32 s84, s84, 10880000
v_and_b32 v2, 31, v0
v_lshlrev_b32 v2, 10, v2
buffer_load_dword v90, v2, s[20:23], s84 offen
s_lshl_b32 s84, s3, 18
s_lshl_b32 s85, s95, 5
s_add_u32 s84, s84, s85
s_add_u32 s84, s84, 11142144
v_lshlrev_b32 v2, 3, v2
buffer_load_dwordx4 v[108:111], v2, s[20:23], s84 offen
buffer_load_dwordx4 v[112:115], v2, s[20:23], s84 offen offset:16
v_lshrrev_b32 v1, 4, v0
v_bfe_u32 v2, v0, 2, 2
v_lshlrev_b32 v2, 2, v2
v_and_b32 v3, 1, v0
v_lshl_add_u32 v2, v3, 1, v2
v_bfe_u32 v3, v0, 1, 1
v_lshl_add_u32 v2, v3, 4, v2
v_mov_b32 v4, 0
v_mov_b32 v5, 0xffff
v_cmp_lt_u32 vcc, v2, v1
s_nop 1
v_cndmask_b32 v6, v4, v5, vcc
v_add_u32 v2, 1, v2
v_mov_b32 v5, 0xffff0000
v_cmp_lt_u32 vcc, v2, v1
s_nop 1
v_cndmask_b32 v7, v4, v5, vcc
v_or_b32 v6, v6, v7
v_lshlrev_b32 v8, 2, v0
v_add_u32 v9, 320, v8
ds_write_b32 v9, v6
v_mov_b32 v5, -1
v_mov_b32 v6, 0x3f803f80
v_cmp_gt_u32 vcc, 80, v0
s_and_b64 exec, exec, vcc
ds_write_b32 v8, v6 offset:2432
ds_write_b32 v8, v4 offset:0
v_cmp_gt_u32 vcc, 16, v0
s_and_b64 exec, exec, vcc
ds_write_b32 v9, v5 offset:2048
s_mov_b64 exec, -1
s_mov_b32 s16, s4
s_and_b32 s17, s5, 0xffff
s_or_b32 s17, s17, 33554432
s_mov_b32 s18, 10000
s_mov_b32 s19, 0x20000
s_mov_b32 s40, s4
s_and_b32 s41, s5, 0xffff
s_mov_b32 s42, 5120000
s_mov_b32 s43, 0x20000
s_mov_b32 s24, s8
s_and_b32 s25, s9, 0xffff
s_mov_b32 s26, 2560
s_mov_b32 s27, 0x20000
s_mov_b32 s28, s10
s_and_b32 s29, s11, 0xffff
s_mov_b32 s30, 16384
s_mov_b32 s31, 0x20000
s_mov_b32 s32, s12
s_and_b32 s33, s13, 0xffff
s_mov_b32 s34, 24576
s_mov_b32 s35, 0x20000
s_mov_b32 s36, s14
s_and_b32 s37, s15, 0xffff
s_mov_b32 s38, 5120000
s_mov_b32 s39, 0x20000
s_mov_b32 s44, 0x05040100
s_mov_b32 s45, 0x07060302
v_and_b32 v91, 15, v0
v_bfe_u32 v1, v0, 4, 2
v_lshlrev_b32 v5, 8, v1
v_lshlrev_b32 v1, 5, v1
s_lshl_b32 s84, s3, 10
s_add_u32 s71, s84, 136192
v_add3_u32 v4, v5, v91, s71
v_and_b32 v6, 31, v0
v_lshlrev_b32 v6, 5, v6
v_add_u32 v6, s71, v6
s_waitcnt lgkmcnt(0)
s_barrier
s_mov_b32 s92, 0
s_waitcnt vmcnt(0)
ds_write_b128 v6, v[108:111]
ds_write_b128 v6, v[112:115] offset:16
v_add_u32 v100, 0, v1
ds_bpermute_b32 v92, v100, v90
v_add_u32 v101, 4, v1
ds_bpermute_b32 v93, v101, v90
v_add_u32 v102, 8, v1
ds_bpermute_b32 v94, v102, v90
v_add_u32 v103, 12, v1
ds_bpermute_b32 v95, v103, v90
v_add_u32 v104, 16, v1
ds_bpermute_b32 v96, v104, v90
v_add_u32 v105, 20, v1
ds_bpermute_b32 v97, v105, v90
v_add_u32 v106, 24, v1
ds_bpermute_b32 v98, v106, v90
v_add_u32 v107, 28, v1
ds_bpermute_b32 v99, v107, v90
s_waitcnt lgkmcnt(0)
main_kernel_round:
v_lshrrev_b32 v228, 20, v92
v_and_b32 v92, 0xfffff, v92
v_cmp_lt_u32 s[46:47], v91, v228
v_add_u32 v92, v92, v91
v_lshlrev_b32 v81, 4, v92
v_lshrrev_b32 v228, 20, v93
v_and_b32 v93, 0xfffff, v93
v_cmp_lt_u32 s[48:49], v91, v228
v_add_u32 v93, v93, v91
v_lshlrev_b32 v82, 4, v93
v_lshrrev_b32 v228, 20, v94
v_and_b32 v94, 0xfffff, v94
v_cmp_lt_u32 s[50:51], v91, v228
v_add_u32 v94, v94, v91
v_lshlrev_b32 v83, 4, v94
v_lshrrev_b32 v228, 20, v95
v_and_b32 v95, 0xfffff, v95
v_cmp_lt_u32 s[52:53], v91, v228
v_add_u32 v95, v95, v91
v_lshlrev_b32 v84, 4, v95
v_lshrrev_b32 v228, 20, v96
v_and_b32 v96, 0xfffff, v96
v_cmp_lt_u32 s[54:55], v91, v228
v_add_u32 v96, v96, v91
v_lshlrev_b32 v85, 4, v96
v_lshrrev_b32 v228, 20, v97
v_and_b32 v97, 0xfffff, v97
v_cmp_lt_u32 s[56:57], v91, v228
v_add_u32 v97, v97, v91
v_lshlrev_b32 v86, 4, v97
v_lshrrev_b32 v228, 20, v98
v_and_b32 v98, 0xfffff, v98
v_cmp_lt_u32 s[58:59], v91, v228
v_add_u32 v98, v98, v91
v_lshlrev_b32 v87, 4, v98
v_lshrrev_b32 v228, 20, v99
v_and_b32 v99, 0xfffff, v99
v_cmp_lt_u32 s[60:61], v91, v228
v_add_u32 v99, v99, v91
v_lshlrev_b32 v88, 4, v99
s_mov_b64 exec, s[46:47]
buffer_load_dwordx4 v[36:39], v81, s[20:23], 0 offen
s_mov_b64 exec, s[48:49]
buffer_load_dwordx4 v[40:43], v82, s[20:23], 0 offen
s_mov_b64 exec, s[50:51]
buffer_load_dwordx4 v[44:47], v83, s[20:23], 0 offen
s_mov_b64 exec, s[52:53]
buffer_load_dwordx4 v[48:51], v84, s[20:23], 0 offen
s_mov_b64 exec, s[54:55]
buffer_load_dwordx4 v[52:55], v85, s[20:23], 0 offen
s_mov_b64 exec, s[56:57]
buffer_load_dwordx4 v[56:59], v86, s[20:23], 0 offen
s_mov_b64 exec, s[58:59]
buffer_load_dwordx4 v[60:63], v87, s[20:23], 0 offen
s_mov_b64 exec, s[60:61]
buffer_load_dwordx4 v[64:67], v88, s[20:23], 0 offen
s_mov_b64 exec, -1
s_mov_b32 s86, 0
s_mov_b32 s74, 0
v_mov_b32 v229, 0
v_mov_b32 v232, s71
v_and_b32 v230, 63, v0
s_cmp_lg_u32 s92, 0
s_cbranch_scc1 main_kernel_noov
s_mov_b32 s87, 17825792
v_cmp_le_u32 vcc, s87, v90
s_mov_b32 s91, 34603008
s_mov_b32 s88, vcc_lo
v_cmp_le_u32 vcc, s91, v90
s_nop 1
s_cmp_eq_u32 vcc_lo, 0
s_cselect_b32 s74, 0, 1
s_cselect_b32 s88, s88, 0
main_kernel_ovl:
s_cmp_eq_u32 s88, 0
s_cbranch_scc1 main_kernel_noov
s_ff1_i32_b32 s87, s88
s_bitset0_b32 s88, s87
v_readlane_b32 s89, v90, s87
s_lshl_b32 s87, s87, 5
s_add_u32 s87, s87, s71
s_add_u32 s87, s87, 16
s_sub_u32 s87, s87, s86
s_lshr_b32 s90, s89, 20
s_sub_u32 s90, s90, 16
s_and_b32 s89, s89, 0xfffff
s_add_u32 s89, s89, 16
s_sub_u32 s89, s89, s86
v_subrev_u32 v231, s86, v230
v_cmp_gt_u32 vcc, s90, v231
v_add_u32 v231, s89, v230
v_add_u32 v233, s87, v230
s_add_u32 s86, s86, s90
v_cndmask_b32 v229, v229, v231, vcc
v_cndmask_b32 v232, v232, v233, vcc
s_branch main_kernel_ovl
main_kernel_noov:
s_min_u32 s87, s86, 64
v_cmp_gt_u32 s[62:63], s87, v230
v_lshlrev_b32 v89, 4, v229
s_nop 3
s_mov_b64 exec, s[62:63]
buffer_load_dwordx4 v[68:71], v89, s[20:23], 0 offen
s_mov_b64 exec, -1
s_cmp_lg_u32 s92, 0
s_cbranch_scc1 main_kernel_lslow
ds_read_u8 v72, v4 offset:0
ds_read_u8 v73, v4 offset:32
ds_read_u8 v74, v4 offset:64
ds_read_u8 v75, v4 offset:96
ds_read_u8 v76, v4 offset:128
ds_read_u8 v77, v4 offset:160
ds_read_u8 v78, v4 offset:192
ds_read_u8 v79, v4 offset:224
ds_read_u8 v80, v232
s_cmp_gt_u32 s86, 64
s_cselect_b32 s74, 1, s74
s_cmp_eq_u32 s74, 0
s_cbranch_scc1 main_kernel_nofl
v_mov_b32 v228, 256
v_mov_b32 v229, 1
ds_write_b32 v228, v229
main_kernel_nofl:
s_waitcnt lgkmcnt(0)
s_branch main_kernel_ljoin
main_kernel_lslow:
s_mov_b32 s87, 10240000
s_mov_b64 exec, s[46:47]
buffer_load_ubyte v72, v92, s[20:23], s87 offen
s_mov_b64 exec, s[48:49]
buffer_load_ubyte v73, v93, s[20:23], s87 offen
s_mov_b64 exec, s[50:51]
buffer_load_ubyte v74, v94, s[20:23], s87 offen
s_mov_b64 exec, s[52:53]
buffer_load_ubyte v75, v95, s[20:23], s87 offen
s_mov_b64 exec, s[54:55]
buffer_load_ubyte v76, v96, s[20:23], s87 offen
s_mov_b64 exec, s[56:57]
buffer_load_ubyte v77, v97, s[20:23], s87 offen
s_mov_b64 exec, s[58:59]
buffer_load_ubyte v78, v98, s[20:23], s87 offen
s_mov_b64 exec, s[60:61]
buffer_load_ubyte v79, v99, s[20:23], s87 offen
s_mov_b64 exec, -1
s_waitcnt vmcnt(0)
main_kernel_ljoin:
v_mov_b32 v228, 1
v_lshlrev_b32 v72, 2, v72
v_lshlrev_b32 v73, 2, v73
v_lshlrev_b32 v74, 2, v74
v_lshlrev_b32 v75, 2, v75
v_lshlrev_b32 v76, 2, v76
v_lshlrev_b32 v77, 2, v77
v_lshlrev_b32 v78, 2, v78
v_lshlrev_b32 v79, 2, v79
v_lshlrev_b32 v80, 2, v80
s_mov_b64 exec, s[46:47]
ds_add_rtn_u32 v81, v72, v228 offset:0
s_mov_b64 exec, s[48:49]
ds_add_rtn_u32 v82, v73, v228 offset:0
s_mov_b64 exec, s[50:51]
ds_add_rtn_u32 v83, v74, v228 offset:0
s_mov_b64 exec, s[52:53]
ds_add_rtn_u32 v84, v75, v228 offset:0
s_mov_b64 exec, s[54:55]
ds_add_rtn_u32 v85, v76, v228 offset:0
s_mov_b64 exec, s[56:57]
ds_add_rtn_u32 v86, v77, v228 offset:0
s_mov_b64 exec, s[58:59]
ds_add_rtn_u32 v87, v78, v228 offset:0
s_mov_b64 exec, s[60:61]
ds_add_rtn_u32 v88, v79, v228 offset:0
s_mov_b64 exec, s[62:63]
ds_add_rtn_u32 v89, v80, v228 offset:0
s_mov_b64 exec, -1
s_waitcnt lgkmcnt(0)
s_barrier
v_and_b32 v1, 63, v0
v_lshlrev_b32 v2, 2, v1
ds_read_b32 v3, v2 offset:0
v_mov_b32 v4, 256
ds_read_b32 v4, v4
s_waitcnt lgkmcnt(0)
v_mov_b32 v5, v3
s_nop 1
v_add_u32_dpp v5, v5, v5 row_shr:1 row_mask:0xf bank_mask:0xf bound_ctrl:0
s_nop 1
v_add_u32_dpp v5, v5, v5 row_shr:2 row_mask:0xf bank_mask:0xf bound_ctrl:0
s_nop 1
v_add_u32_dpp v5, v5, v5 row_shr:4 row_mask:0xf bank_mask:0xf bound_ctrl:0
s_nop 1
v_add_u32_dpp v5, v5, v5 row_shr:8 row_mask:0xf bank_mask:0xf bound_ctrl:0
s_nop 1
v_add_u32_dpp v5, v5, v5 row_bcast:15 row_mask:0xa bank_mask:0xf
s_nop 1
v_add_u32_dpp v5, v5, v5 row_bcast:31 row_mask:0xc bank_mask:0xf
v_sub_u32 v7, v5, v3
v_readlane_b32 s86, v5, 63
v_readfirstlane_b32 s87, v4
v_cmp_gt_u32 vcc, 40, v1
v_mov_b32 v252, 0x7fffffff
s_nop 0
v_cndmask_b32 v252, v252, v5, vcc
s_add_u32 s88, s86, 31
s_lshr_b32 s88, s88, 5
s_max_u32 s88, s88, 1
s_cmp_lg_u32 s92, 0
s_cbranch_scc1 main_kernel_fits
s_cmp_gt_u32 s88, 92
s_cbranch_scc1 main_kernel_slow
s_cmp_lg_u32 s87, 0
s_cbranch_scc1 main_kernel_slow
main_kernel_fits:
ds_bpermute_b32 v100, v72, v7
ds_bpermute_b32 v101, v73, v7
ds_bpermute_b32 v102, v74, v7
ds_bpermute_b32 v103, v75, v7
ds_bpermute_b32 v104, v76, v7
ds_bpermute_b32 v105, v77, v7
ds_bpermute_b32 v106, v78, v7
ds_bpermute_b32 v107, v79, v7
ds_bpermute_b32 v108, v80, v7
s_mov_b32 s13, s88
s_waitcnt lgkmcnt(8)
v_add_u32 v81, v81, v100
v_lshlrev_b32 v81, 4, v81
s_waitcnt lgkmcnt(7)
v_add_u32 v82, v82, v101
v_lshlrev_b32 v82, 4, v82
s_waitcnt lgkmcnt(6)
v_add_u32 v83, v83, v102
v_lshlrev_b32 v83, 4, v83
s_waitcnt lgkmcnt(5)
v_add_u32 v84, v84, v103
v_lshlrev_b32 v84, 4, v84
s_waitcnt lgkmcnt(4)
v_add_u32 v85, v85, v104
v_lshlrev_b32 v85, 4, v85
s_waitcnt lgkmcnt(3)
v_add_u32 v86, v86, v105
v_lshlrev_b32 v86, 4, v86
s_waitcnt lgkmcnt(2)
v_add_u32 v87, v87, v106
v_lshlrev_b32 v87, 4, v87
s_waitcnt lgkmcnt(1)
v_add_u32 v88, v88, v107
v_lshlrev_b32 v88, 4, v88
s_waitcnt lgkmcnt(0)
v_add_u32 v89, v89, v108
v_lshlrev_b32 v89, 4, v89
s_cmp_lg_u32 s92, 0
s_cbranch_scc1 main_kernel_nowt
v_and_b32 v8, 63, v0
v_lshrrev_b32 v9, 3, v8
v_bfe_u32 v10, v8, 1, 2
v_bfe_u32 v11, v8, 4, 1
v_xor_b32 v10, v10, v11
v_lshlrev_b32 v9, 7, v9
v_lshl_add_u32 v9, v10, 5, v9
v_and_b32 v10, 1, v8
v_lshl_add_u32 v9, v10, 4, v9
v_xor_b32 v10, 64, v9
s_lshl_b32 s87, s3, 11
s_add_u32 s88, s87, 52992
s_mov_b32 m0, s88
s_add_u32 s89, s87, 1024
buffer_load_dwordx4 v9, s[28:31], s87 offen lds
s_add_u32 s88, s88, 1024
s_mov_b32 m0, s88
s_nop 0
buffer_load_dwordx4 v10, s[28:31], s89 offen lds
s_mul_i32 s87, s3, 3072
s_add_u32 s89, s3, 0
s_and_b32 s89, s89, 1
s_lshl_b32 s89, s89, 6
v_xor_b32 v11, s89, v9
s_add_u32 s89, s87, 0
s_add_u32 s88, s89, 69376
s_mov_b32 m0, s88
s_nop 0
buffer_load_dwordx4 v11, s[32:35], s89 offen lds
s_add_u32 s89, s3, 1
s_and_b32 s89, s89, 1
s_lshl_b32 s89, s89, 6
v_xor_b32 v11, s89, v9
s_add_u32 s89, s87, 1024
s_add_u32 s88, s89, 69376
s_mov_b32 m0, s88
s_nop 0
buffer_load_dwordx4 v11, s[32:35], s89 offen lds
s_add_u32 s89, s3, 2
s_and_b32 s89, s89, 1
s_lshl_b32 s89, s89, 6
v_xor_b32 v11, s89, v9
s_add_u32 s89, s87, 2048
s_add_u32 s88, s89, 69376
s_mov_b32 m0, s88
s_nop 0
buffer_load_dwordx4 v11, s[32:35], s89 offen lds
s_mul_hi_u32 s87, s3, 0x55555556
s_mul_i32 s87, s87, 3
s_sub_u32 s87, s3, s87
s_lshl_b32 s87, s87, 10
s_add_u32 s88, s87, 2816
s_mov_b32 m0, s88
v_lshlrev_b32 v11, 4, v8
buffer_load_dwordx4 v11, s[24:27], s87 offen lds
main_kernel_nowt:
s_waitcnt vmcnt(14)
s_mov_b64 exec, s[46:47]
ds_write_b128 v81, v[36:39] offset:5888
s_waitcnt vmcnt(13)
s_mov_b64 exec, s[48:49]
ds_write_b128 v82, v[40:43] offset:5888
s_waitcnt vmcnt(12)
s_mov_b64 exec, s[50:51]
ds_write_b128 v83, v[44:47] offset:5888
s_waitcnt vmcnt(11)
s_mov_b64 exec, s[52:53]
ds_write_b128 v84, v[48:51] offset:5888
s_waitcnt vmcnt(10)
s_mov_b64 exec, s[54:55]
ds_write_b128 v85, v[52:55] offset:5888
s_waitcnt vmcnt(9)
s_mov_b64 exec, s[56:57]
ds_write_b128 v86, v[56:59] offset:5888
s_waitcnt vmcnt(8)
s_mov_b64 exec, s[58:59]
ds_write_b128 v87, v[60:63] offset:5888
s_waitcnt vmcnt(7)
s_mov_b64 exec, s[60:61]
ds_write_b128 v88, v[64:67] offset:5888
s_waitcnt vmcnt(6)
s_mov_b64 exec, s[62:63]
ds_write_b128 v89, v[68:71] offset:5888
s_mov_b64 exec, -1
s_cmp_lg_u32 s92, 0
s_cbranch_scc1 main_kernel_pf2
s_lshr_b32 s84, s2, 3
s_mul_i32 s84, s84, 160256
s_mul_i32 s85, s3, 19968
s_add_u32 s84, s84, s85
v_and_b32 v8, 63, v0
v_lshrrev_b32 v9, 1, v8
v_lshlrev_b32 v9, 9, v9
v_and_b32 v10, 1, v8
v_lshl_add_u32 v9, v10, 7, v9
v_cmp_gt_u32 vcc, 32, v8
s_and_b64 exec, exec, vcc
buffer_load_dword v254, v9, s[40:43], s84 offen
s_mov_b64 exec, -1
main_kernel_pf2:
s_sub_u32 s55, 7, s3
s_cmp_ge_u32 s13, 8
s_cselect_b32 s55, s55, s3
s_mul_i32 s67, s3, s13
s_add_u32 s68, s67, s13
s_lshr_b32 s67, s67, 3
s_lshr_b32 s68, s68, 3
s_sub_u32 s75, s68, s67
s_lshl_b32 s67, s67, 5
s_lshl_b32 s68, s68, 5
s_mul_i32 s46, s55, s13
s_add_u32 s47, s46, s13
s_lshr_b32 s46, s46, 3
s_lshr_b32 s47, s47, 3
s_sub_u32 s48, s47, s46
s_lshl_b32 s46, s46, 5
s_lshl_b32 s47, s47, 5
s_lshl_b32 s84, s13, 5
s_sub_u32 s84, s84, s86
v_add_u32 v2, s86, v1
v_lshlrev_b32 v2, 4, v2
v_mov_b32 v228, 0
v_mov_b32 v229, 0
v_mov_b32 v230, 0
v_mov_b32 v231, 0xffff0000
v_cmp_gt_u32 vcc, s84, v1
s_and_b64 exec, exec, vcc
ds_write_b128 v2, v[228:231] offset:5888
s_mov_b64 exec, -1
v_bfe_u32 v8, v0, 4, 2
v_lshlrev_b32 v9, 6, v8
s_lshl_b32 s84, s67, 4
s_add_u32 s84, s84, 5888
v_add_u32 v9, s84, v9
v_add_u32 v5, 14, v9
v_and_b32 v10, 3, v0
v_lshl_add_u32 v1, v10, 1, v9
v_bfe_u32 v10, v0, 2, 2
v_lshl_add_u32 v11, v10, 1, v9
v_add_u32 v11, 6, v11
v_cmp_eq_u32 vcc, 0, v10
v_mov_b32 v12, 2432
v_mov_b32 v13, -1
v_mov_b32 v14, 0
v_cndmask_b32 v2, v11, v12, vcc
v_cndmask_b32 v3, v13, v14, vcc
v_lshlrev_b32 v6, 4, v8
v_add_u32 v6, 320, v6
v_and_b32 v10, 15, v0
v_lshlrev_b32 v11, 7, v8
v_lshrrev_b32 v12, 3, v10
v_lshl_add_u32 v11, v12, 9, v11
v_and_b32 v12, 7, v10
v_lshl_add_u32 v11, v12, 4, v11
v_add_u32 v253, 52992, v11
v_lshlrev_b32 v10, 4, v10
v_mov_b32 v9, v10
v_mov_b32 v11, v10
v_mov_b32 v13, v10
v_mov_b32 v15, v10
v_mov_b32 v17, v10
v_mov_b32 v19, v10
v_mov_b32 v21, v10
v_mov_b32 v23, v10
s_mov_b32 s69, 0
s_mov_b32 s50, 0
v_bfe_u32 v228, v0, 4, 2
v_bfe_u32 v229, v0, 2, 2
v_and_b32 v230, 3, v0
v_lshrrev_b32 v232, 1, v229
v_and_b32 v233, 1, v228
v_lshl_add_u32 v232, v233, 1, v232
s_and_b32 s84, s3, 1
s_lshl_b32 s84, s84, 1
v_lshrrev_b32 v233, 1, v230
v_add_u32 v233, s84, v233
v_xor_b32 v232, v233, v232
v_lshlrev_b32 v231, 3, v228
v_add_u32 v231, v231, v229
v_lshlrev_b32 v231, 7, v231
v_lshl_add_u32 v231, v232, 5, v231
v_and_b32 v233, 1, v230
v_lshl_add_u32 v231, v233, 4, v231
v_add_u32 v4, 52992, v231
s_waitcnt vmcnt(1) lgkmcnt(0)
s_barrier
s_cmp_lg_u32 s75, 0
s_cbranch_scc1 main_kernel_hasg
s_cmp_lg_u32 s92, 0
s_cbranch_scc1 main_kernel_e_nf2
s_cmp_lt_u32 s3, 2
s_mov_b32 s85, 16384
s_cselect_b32 s85, 0, s85
v_add_u32 v7, s85, v4
ds_read_b64_tr_b16 v[164:165], v7 offset:0
ds_read_b64_tr_b16 v[166:167], v7 offset:512
ds_read_b64_tr_b16 v[168:169], v7 offset:8
ds_read_b64_tr_b16 v[170:171], v7 offset:520
ds_read_b64_tr_b16 v[172:173], v7 offset:4096
ds_read_b64_tr_b16 v[174:175], v7 offset:4608
ds_read_b64_tr_b16 v[176:177], v7 offset:4104
ds_read_b64_tr_b16 v[178:179], v7 offset:4616
s_mov_b32 s85, 24576
s_cselect_b32 s85, 8192, s85
v_add_u32 v7, s85, v4
ds_read_b64_tr_b16 v[180:181], v7 offset:0
ds_read_b64_tr_b16 v[182:183], v7 offset:512
ds_read_b64_tr_b16 v[184:185], v7 offset:8
ds_read_b64_tr_b16 v[186:187], v7 offset:520
ds_read_b64_tr_b16 v[188:189], v7 offset:4096
ds_read_b64_tr_b16 v[190:191], v7 offset:4608
ds_read_b64_tr_b16 v[192:193], v7 offset:4104
ds_read_b64_tr_b16 v[194:195], v7 offset:4616
s_mov_b32 s85, 32768
s_cselect_b32 s85, 8192, s85
v_add_u32 v7, s85, v4
ds_read_b64_tr_b16 v[196:197], v7 offset:0
ds_read_b64_tr_b16 v[198:199], v7 offset:512
ds_read_b64_tr_b16 v[200:201], v7 offset:8
ds_read_b64_tr_b16 v[202:203], v7 offset:520
ds_read_b64_tr_b16 v[204:205], v7 offset:4096
ds_read_b64_tr_b16 v[206:207], v7 offset:4608
ds_read_b64_tr_b16 v[208:209], v7 offset:4104
ds_read_b64_tr_b16 v[210:211], v7 offset:4616
v_mov_b32 v7, 264
v_mov_b32 v4, 1
s_mov_b64 exec, 1
ds_add_u32 v7, v4
s_mov_b64 exec, -1
main_kernel_e_nf2:
s_mov_b32 s52, 0
s_mov_b32 s66, 0
s_mov_b32 s49, 0
s_mov_b32 s87, -1
s_mul_i32 s84, s13, 1
s_lshr_b32 s84, s84, 3
s_lshl_b32 s84, s84, 5
v_cmp_ge_u32 vcc, s84, v252
s_nop 1
s_bcnt1_i32_b64 s85, vcc
s_cmp_eq_u32 s3, 1
s_cselect_b32 s66, s85, s66
s_cmp_eq_u32 s55, 1
s_cselect_b32 s49, s85, s49
s_mov_b32 s87, s85
s_mul_i32 s84, s13, 2
s_lshr_b32 s84, s84, 3
s_lshl_b32 s84, s84, 5
v_cmp_ge_u32 vcc, s84, v252
s_nop 1
s_bcnt1_i32_b64 s85, vcc
s_cmp_eq_u32 s85, s87
s_cselect_b32 s86, 2, 0
s_cmp_lt_u32 s85, 40
s_cselect_b32 s86, s86, 0
s_or_b32 s52, s52, s86
s_cmp_eq_u32 s3, 2
s_cselect_b32 s66, s85, s66
s_cmp_eq_u32 s55, 2
s_cselect_b32 s49, s85, s49
s_mov_b32 s87, s85
s_mul_i32 s84, s13, 3
s_lshr_b32 s84, s84, 3
s_lshl_b32 s84, s84, 5
v_cmp_ge_u32 vcc, s84, v252
s_nop 1
s_bcnt1_i32_b64 s85, vcc
s_cmp_eq_u32 s85, s87
s_cselect_b32 s86, 4, 0
s_cmp_lt_u32 s85, 40
s_cselect_b32 s86, s86, 0
s_or_b32 s52, s52, s86
s_cmp_eq_u32 s3, 3
s_cselect_b32 s66, s85, s66
s_cmp_eq_u32 s55, 3
s_cselect_b32 s49, s85, s49
s_mov_b32 s87, s85
s_mul_i32 s84, s13, 4
s_lshr_b32 s84, s84, 3
s_lshl_b32 s84, s84, 5
v_cmp_ge_u32 vcc, s84, v252
s_nop 1
s_bcnt1_i32_b64 s85, vcc
s_cmp_eq_u32 s85, s87
s_cselect_b32 s86, 8, 0
s_cmp_lt_u32 s85, 40
s_cselect_b32 s86, s86, 0
s_or_b32 s52, s52, s86
s_cmp_eq_u32 s3, 4
s_cselect_b32 s66, s85, s66
s_cmp_eq_u32 s55, 4
s_cselect_b32 s49, s85, s49
s_mov_b32 s87, s85
s_mul_i32 s84, s13, 5
s_lshr_b32 s84, s84, 3
s_lshl_b32 s84, s84, 5
v_cmp_ge_u32 vcc, s84, v252
s_nop 1
s_bcnt1_i32_b64 s85, vcc
s_cmp_eq_u32 s85, s87
s_cselect_b32 s86, 16, 0
s_cmp_lt_u32 s85, 40
s_cselect_b32 s86, s86, 0
s_or_b32 s52, s52, s86
s_cmp_eq_u32 s3, 5
s_cselect_b32 s66, s85, s66
s_cmp_eq_u32 s55, 5
s_cselect_b32 s49, s85, s49
s_mov_b32 s87, s85
s_mul_i32 s84, s13, 6
s_lshr_b32 s84, s84, 3
s_lshl_b32 s84, s84, 5
v_cmp_ge_u32 vcc, s84, v252
s_nop 1
s_bcnt1_i32_b64 s85, vcc
s_cmp_eq_u32 s85, s87
s_cselect_b32 s86, 32, 0
s_cmp_lt_u32 s85, 40
s_cselect_b32 s86, s86, 0
s_or_b32 s52, s52, s86
s_cmp_eq_u32 s3, 6
s_cselect_b32 s66, s85, s66
s_cmp_eq_u32 s55, 6
s_cselect_b32 s49, s85, s49
s_mov_b32 s87, s85
s_mul_i32 s84, s13, 7
s_lshr_b32 s84, s84, 3
s_lshl_b32 s84, s84, 5
v_cmp_ge_u32 vcc, s84, v252
s_nop 1
s_bcnt1_i32_b64 s85, vcc
s_cmp_eq_u32 s85, s87
s_cselect_b32 s86, 64, 0
s_cmp_lt_u32 s85, 40
s_cselect_b32 s86, s86, 0
s_or_b32 s52, s52, s86
s_cmp_eq_u32 s3, 7
s_cselect_b32 s66, s85, s66
s_cmp_eq_u32 s55, 7
s_cselect_b32 s49, s85, s49
s_mov_b32 s87, s85
s_mul_i32 s84, s13, 8
s_lshr_b32 s84, s84, 3
s_lshl_b32 s84, s84, 5
v_cmp_ge_u32 vcc, s84, v252
s_nop 1
s_bcnt1_i32_b64 s85, vcc
s_cmp_eq_u32 s85, s87
s_cselect_b32 s86, 128, 0
s_cmp_lt_u32 s85, 40
s_cselect_b32 s86, s86, 0
s_or_b32 s52, s52, s86
s_mov_b32 s87, s85
s_cmp_eq_u32 s67, 0
s_cselect_b32 s66, 0, s66
s_cmp_eq_u32 s46, 0
s_cselect_b32 s49, 0, s49
s_not_b32 s84, s52
s_sub_u32 s85, 31, s3
s_lshl_b32 s84, s84, s85
s_flbit_i32_b32 s53, s84
s_not_b32 s84, s52
s_sub_u32 s85, 31, s55
s_lshl_b32 s84, s84, s85
s_flbit_i32_b32 s54, s84
s_branch main_kernel_endmain
main_kernel_hasg:
s_mov_b32 s76, s67
s_mov_b32 s78, s75
s_mov_b32 s72, s75
s_mov_b32 s79, 0
s_mov_b32 s82, 0
s_sub_u32 s84, s46, s68
s_add_u32 s84, s84, 32
s_lshl_b32 s73, s84, 4
s_add_u32 s83, s75, s48
s_sub_u32 s83, s83, 1
ds_read_u16 v8, v5 offset:0
ds_read_u16 v10, v5 offset:16
ds_read_u16 v12, v5 offset:32
ds_read_u16 v14, v5 offset:48
ds_read_u16 v16, v5 offset:256
ds_read_u16 v18, v5 offset:272
ds_read_u16 v20, v5 offset:288
ds_read_u16 v22, v5 offset:304
s_waitcnt lgkmcnt(0)
s_cmp_lg_u32 s92, 0
s_cbranch_scc1 main_kernel_nf2
s_cmp_lt_u32 s3, 2
s_mov_b32 s85, 16384
s_cselect_b32 s85, 0, s85
v_add_u32 v7, s85, v4
ds_read_b64_tr_b16 v[164:165], v7 offset:0
ds_read_b64_tr_b16 v[166:167], v7 offset:512
ds_read_b64_tr_b16 v[168:169], v7 offset:8
ds_read_b64_tr_b16 v[170:171], v7 offset:520
ds_read_b64_tr_b16 v[172:173], v7 offset:4096
ds_read_b64_tr_b16 v[174:175], v7 offset:4608
ds_read_b64_tr_b16 v[176:177], v7 offset:4104
ds_read_b64_tr_b16 v[178:179], v7 offset:4616
s_mov_b32 s85, 24576
s_cselect_b32 s85, 8192, s85
v_add_u32 v7, s85, v4
ds_read_b64_tr_b16 v[180:181], v7 offset:0
ds_read_b64_tr_b16 v[182:183], v7 offset:512
ds_read_b64_tr_b16 v[184:185], v7 offset:8
ds_read_b64_tr_b16 v[186:187], v7 offset:520
ds_read_b64_tr_b16 v[188:189], v7 offset:4096
ds_read_b64_tr_b16 v[190:191], v7 offset:4608
ds_read_b64_tr_b16 v[192:193], v7 offset:4104
ds_read_b64_tr_b16 v[194:195], v7 offset:4616
s_mov_b32 s85, 32768
s_cselect_b32 s85, 8192, s85
v_add_u32 v7, s85, v4
ds_read_b64_tr_b16 v[196:197], v7 offset:0
ds_read_b64_tr_b16 v[198:199], v7 offset:512
ds_read_b64_tr_b16 v[200:201], v7 offset:8
ds_read_b64_tr_b16 v[202:203], v7 offset:520
ds_read_b64_tr_b16 v[204:205], v7 offset:4096
ds_read_b64_tr_b16 v[206:207], v7 offset:4608
ds_read_b64_tr_b16 v[208:209], v7 offset:4104
ds_read_b64_tr_b16 v[210:211], v7 offset:4616
v_mov_b32 v7, 264
v_mov_b32 v4, 1
s_mov_b64 exec, 1
ds_add_u32 v7, v4
s_mov_b64 exec, -1
main_kernel_nf2:
buffer_load_dwordx4 v[36:39], v[8:9], s[16:19], s79 idxen offen
buffer_load_dwordx4 v[40:43], v[10:11], s[16:19], s79 idxen offen
buffer_load_dwordx4 v[44:47], v[12:13], s[16:19], s79 idxen offen
buffer_load_dwordx4 v[48:51], v[14:15], s[16:19], s79 idxen offen
buffer_load_dwordx4 v[52:55], v[16:17], s[16:19], s79 idxen offen
buffer_load_dwordx4 v[56:59], v[18:19], s[16:19], s79 idxen offen
buffer_load_dwordx4 v[60:63], v[20:21], s[16:19], s79 idxen offen
buffer_load_dwordx4 v[64:67], v[22:23], s[16:19], s79 idxen offen
s_sub_u32 s78, s78, 1
s_cmp_eq_u32 s78, 0
s_cselect_b32 s84, s73, 0x200
s_cselect_b32 s78, s48, s78
s_cselect_b32 s79, 0x100, s79
v_add_u32 v5, s84, v5
s_mov_b32 s52, 0
s_mov_b32 s66, 0
s_mov_b32 s49, 0
s_mov_b32 s87, -1
s_mul_i32 s84, s13, 1
s_lshr_b32 s84, s84, 3
s_lshl_b32 s84, s84, 5
v_cmp_ge_u32 vcc, s84, v252
s_nop 1
s_bcnt1_i32_b64 s85, vcc
s_cmp_eq_u32 s3, 1
s_cselect_b32 s66, s85, s66
s_cmp_eq_u32 s55, 1
s_cselect_b32 s49, s85, s49
s_mov_b32 s87, s85
s_mul_i32 s84, s13, 2
s_lshr_b32 s84, s84, 3
s_lshl_b32 s84, s84, 5
v_cmp_ge_u32 vcc, s84, v252
s_nop 1
s_bcnt1_i32_b64 s85, vcc
s_cmp_eq_u32 s85, s87
s_cselect_b32 s86, 2, 0
s_cmp_lt_u32 s85, 40
s_cselect_b32 s86, s86, 0
s_or_b32 s52, s52, s86
s_cmp_eq_u32 s3, 2
s_cselect_b32 s66, s85, s66
s_cmp_eq_u32 s55, 2
s_cselect_b32 s49, s85, s49
s_mov_b32 s87, s85
s_mul_i32 s84, s13, 3
s_lshr_b32 s84, s84, 3
s_lshl_b32 s84, s84, 5
v_cmp_ge_u32 vcc, s84, v252
s_nop 1
s_bcnt1_i32_b64 s85, vcc
s_cmp_eq_u32 s85, s87
s_cselect_b32 s86, 4, 0
s_cmp_lt_u32 s85, 40
s_cselect_b32 s86, s86, 0
s_or_b32 s52, s52, s86
s_cmp_eq_u32 s3, 3
s_cselect_b32 s66, s85, s66
s_cmp_eq_u32 s55, 3
s_cselect_b32 s49, s85, s49
s_mov_b32 s87, s85
s_mul_i32 s84, s13, 4
s_lshr_b32 s84, s84, 3
s_lshl_b32 s84, s84, 5
v_cmp_ge_u32 vcc, s84, v252
s_nop 1
s_bcnt1_i32_b64 s85, vcc
s_cmp_eq_u32 s85, s87
s_cselect_b32 s86, 8, 0
s_cmp_lt_u32 s85, 40
s_cselect_b32 s86, s86, 0
s_or_b32 s52, s52, s86
s_cmp_eq_u32 s3, 4
s_cselect_b32 s66, s85, s66
s_cmp_eq_u32 s55, 4
s_cselect_b32 s49, s85, s49
s_mov_b32 s87, s85
s_mul_i32 s84, s13, 5
s_lshr_b32 s84, s84, 3
s_lshl_b32 s84, s84, 5
v_cmp_ge_u32 vcc, s84, v252
s_nop 1
s_bcnt1_i32_b64 s85, vcc
s_cmp_eq_u32 s85, s87
s_cselect_b32 s86, 16, 0
s_cmp_lt_u32 s85, 40
s_cselect_b32 s86, s86, 0
s_or_b32 s52, s52, s86
s_cmp_eq_u32 s3, 5
s_cselect_b32 s66, s85, s66
s_cmp_eq_u32 s55, 5
s_cselect_b32 s49, s85, s49
s_mov_b32 s87, s85
s_mul_i32 s84, s13, 6
s_lshr_b32 s84, s84, 3
s_lshl_b32 s84, s84, 5
v_cmp_ge_u32 vcc, s84, v252
s_nop 1
s_bcnt1_i32_b64 s85, vcc
s_cmp_eq_u32 s85, s87
s_cselect_b32 s86, 32, 0
s_cmp_lt_u32 s85, 40
s_cselect_b32 s86, s86, 0
s_or_b32 s52, s52, s86
s_cmp_eq_u32 s3, 6
s_cselect_b32 s66, s85, s66
s_cmp_eq_u32 s55, 6
s_cselect_b32 s49, s85, s49
s_mov_b32 s87, s85
s_mul_i32 s84, s13, 7
s_lshr_b32 s84, s84, 3
s_lshl_b32 s84, s84, 5
v_cmp_ge_u32 vcc, s84, v252
s_nop 1
s_bcnt1_i32_b64 s85, vcc
s_cmp_eq_u32 s85, s87
s_cselect_b32 s86, 64, 0
s_cmp_lt_u32 s85, 40
s_cselect_b32 s86, s86, 0
s_or_b32 s52, s52, s86
s_cmp_eq_u32 s3, 7
s_cselect_b32 s66, s85, s66
s_cmp_eq_u32 s55, 7
s_cselect_b32 s49, s85, s49
s_mov_b32 s87, s85
s_mul_i32 s84, s13, 8
s_lshr_b32 s84, s84, 3
s_lshl_b32 s84, s84, 5
v_cmp_ge_u32 vcc, s84, v252
s_nop 1
s_bcnt1_i32_b64 s85, vcc
s_cmp_eq_u32 s85, s87
s_cselect_b32 s86, 128, 0
s_cmp_lt_u32 s85, 40
s_cselect_b32 s86, s86, 0
s_or_b32 s52, s52, s86
s_mov_b32 s87, s85
s_cmp_eq_u32 s67, 0
s_cselect_b32 s66, 0, s66
s_cmp_eq_u32 s46, 0
s_cselect_b32 s49, 0, s49
s_not_b32 s84, s52
s_sub_u32 s85, 31, s3
s_lshl_b32 s84, s84, s85
s_flbit_i32_b32 s53, s84
s_not_b32 s84, s52
s_sub_u32 s85, 31, s55
s_lshl_b32 s84, s84, s85
s_flbit_i32_b32 s54, s84
s_mov_b32 s65, s66
v_readlane_b32 s64, v252, s65
s_mul_i32 s80, s65, 2080
v_bfe_u32 v86, v0, 3, 3
v_lshlrev_b32 v86, 2, v86
s_mov_b32 s84, 1120014896
v_lshrrev_b32 v86, v86, s84
v_bfe_u32 v85, v86, 3, 1
v_and_b32 v86, 7, v86
v_lshlrev_b32 v86, 7, v86
v_and_b32 v84, 7, v0
v_lshl_add_u32 v84, v84, 4, v86
s_mov_b32 s84, 0x80008000
v_mul_lo_u32 v85, v85, s84
ds_read_b128 v[68:71], v84 offset:2816
ds_read_b128 v[72:75], v84 offset:3456
ds_read_b128 v[76:79], v84 offset:4096
ds_read_b128 v[80:83], v84 offset:4736
s_waitcnt lgkmcnt(3)
v_xor_b32 v68, v68, v85
v_xor_b32 v69, v69, v85
v_xor_b32 v70, v70, v85
v_xor_b32 v71, v71, v85
v_lshlrev_b32 v132, 16, v68
v_and_b32 v136, 0xffff0000, v68
v_lshlrev_b32 v140, 16, v69
v_and_b32 v144, 0xffff0000, v69
v_lshlrev_b32 v148, 16, v70
v_and_b32 v152, 0xffff0000, v70
v_lshlrev_b32 v156, 16, v71
v_and_b32 v160, 0xffff0000, v71
s_waitcnt lgkmcnt(2)
v_xor_b32 v72, v72, v85
v_xor_b32 v73, v73, v85
v_xor_b32 v74, v74, v85
v_xor_b32 v75, v75, v85
v_lshlrev_b32 v133, 16, v72
v_and_b32 v137, 0xffff0000, v72
v_lshlrev_b32 v141, 16, v73
v_and_b32 v145, 0xffff0000, v73
v_lshlrev_b32 v149, 16, v74
v_and_b32 v153, 0xffff0000, v74
v_lshlrev_b32 v157, 16, v75
v_and_b32 v161, 0xffff0000, v75
s_waitcnt lgkmcnt(1)
v_xor_b32 v76, v76, v85
v_xor_b32 v77, v77, v85
v_xor_b32 v78, v78, v85
v_xor_b32 v79, v79, v85
v_lshlrev_b32 v134, 16, v76
v_and_b32 v138, 0xffff0000, v76
v_lshlrev_b32 v142, 16, v77
v_and_b32 v146, 0xffff0000, v77
v_lshlrev_b32 v150, 16, v78
v_and_b32 v154, 0xffff0000, v78
v_lshlrev_b32 v158, 16, v79
v_and_b32 v162, 0xffff0000, v79
s_waitcnt lgkmcnt(0)
v_xor_b32 v80, v80, v85
v_xor_b32 v81, v81, v85
v_xor_b32 v82, v82, v85
v_xor_b32 v83, v83, v85
v_lshlrev_b32 v135, 16, v80
v_and_b32 v139, 0xffff0000, v80
v_lshlrev_b32 v143, 16, v81
v_and_b32 v147, 0xffff0000, v81
v_lshlrev_b32 v151, 16, v82
v_and_b32 v155, 0xffff0000, v82
v_lshlrev_b32 v159, 16, v83
v_and_b32 v163, 0xffff0000, v83
ds_read_u16 v8, v5 offset:0
ds_read_u16 v10, v5 offset:16
ds_read_u16 v12, v5 offset:32
ds_read_u16 v14, v5 offset:48
ds_read_u16 v16, v5 offset:256
ds_read_u16 v18, v5 offset:272
ds_read_u16 v20, v5 offset:288
ds_read_u16 v22, v5 offset:304
ds_read_u16_d16_hi v212, v1 offset:0
ds_read_u16_d16_hi v220, v2 offset:0
ds_read_u16_d16_hi v213, v1 offset:16
ds_read_u16_d16_hi v221, v2 offset:16
ds_read_u16_d16_hi v214, v1 offset:32
ds_read_u16_d16_hi v222, v2 offset:32
ds_read_u16_d16_hi v215, v1 offset:48
ds_read_u16_d16_hi v223, v2 offset:48
ds_read_u16_d16_hi v216, v1 offset:256
ds_read_u16_d16_hi v224, v2 offset:256
ds_read_u16_d16_hi v217, v1 offset:272
ds_read_u16_d16_hi v225, v2 offset:272
ds_read_u16_d16_hi v218, v1 offset:288
ds_read_u16_d16_hi v226, v2 offset:288
ds_read_u16_d16_hi v219, v1 offset:304
ds_read_u16_d16_hi v227, v2 offset:304
s_sub_u32 s72, s72, 1
s_cmp_eq_u32 s72, 0
s_cselect_b32 s84, s73, 0x200
s_cselect_b32 s72, s48, s72
v_add_u32 v1, s84, v1
v_and_b32 v7, s84, v3
v_add_u32 v2, v7, v2
s_sub_u32 s84, s64, s76
s_min_u32 s84, s84, 32
s_lshl_b32 s84, s84, 6
v_add_u32 v7, s84, v6
ds_read_b128 v[32:35], v7
v_mov_b32 v100, 0
v_mov_b32 v101, 0
v_mov_b32 v102, 0
v_mov_b32 v103, 0
v_mov_b32 v104, 0
v_mov_b32 v105, 0
v_mov_b32 v106, 0
v_mov_b32 v107, 0
v_mov_b32 v108, 0
v_mov_b32 v109, 0
v_mov_b32 v110, 0
v_mov_b32 v111, 0
v_mov_b32 v112, 0
v_mov_b32 v113, 0
v_mov_b32 v114, 0
v_mov_b32 v115, 0
v_mov_b32 v116, 0
v_mov_b32 v117, 0
v_mov_b32 v118, 0
v_mov_b32 v119, 0
v_mov_b32 v120, 0
v_mov_b32 v121, 0
v_mov_b32 v122, 0
v_mov_b32 v123, 0
v_mov_b32 v124, 0
v_mov_b32 v125, 0
v_mov_b32 v126, 0
v_mov_b32 v127, 0
v_mov_b32 v128, 0
v_mov_b32 v129, 0
v_mov_b32 v130, 0
v_mov_b32 v131, 0
s_waitcnt lgkmcnt(1)
v_mul_f32 v212, v212, v220
v_mul_f32 v213, v213, v221
v_mul_f32 v214, v214, v222
v_mul_f32 v215, v215, v223
v_mul_f32 v216, v216, v224
v_mul_f32 v217, v217, v225
v_mul_f32 v218, v218, v226
v_mul_f32 v219, v219, v227
v_cvt_pk_bf16_f32 v24, v212, v213
v_cvt_pk_bf16_f32 v25, v214, v215
v_cvt_pk_bf16_f32 v26, v216, v217
v_cvt_pk_bf16_f32 v27, v218, v219
s_cmp_lg_u32 s92, 0
s_cbranch_scc1 main_kernel_wok
v_mov_b32 v7, 264
main_kernel_wspin:
ds_read_b32 v4, v7
s_waitcnt lgkmcnt(0)
v_readfirstlane_b32 s84, v4
s_nop 3
s_cmp_lt_u32 s84, 8
s_cbranch_scc1 main_kernel_wspin
main_kernel_wok:
s_cmp_ge_u32 s3, 4
s_cbranch_scc0 main_kernel_p0_1
s_setprio 1
s_branch main_kernel_p1_2
main_kernel_p0_1:
s_setprio 0
main_kernel_p1_2:
s_mul_i32 s62, s48, 4
s_lshr_b32 s62, s62, 3
main_kernel_loop:
s_add_u32 s77, s76, 32
s_cmp_le_u32 s64, s77
s_cbranch_scc1 main_kernel_v_pb_3
s_waitcnt vmcnt(0)
v_perm_b32 v68, v40, v36, s44
v_perm_b32 v69, v48, v44, s44
v_perm_b32 v70, v56, v52, s44
v_perm_b32 v71, v64, v60, s44
v_perm_b32 v72, v40, v36, s45
v_perm_b32 v73, v48, v44, s45
v_perm_b32 v74, v56, v52, s45
v_perm_b32 v75, v64, v60, s45
v_mfma_f32_16x16x32_bf16 v[100:103], v[24:27], v[68:71], v[100:103]
v_perm_b32 v76, v41, v37, s44
v_perm_b32 v77, v49, v45, s44
v_perm_b32 v78, v57, v53, s44
v_perm_b32 v79, v65, v61, s44
v_mfma_f32_16x16x32_bf16 v[104:107], v[24:27], v[72:75], v[104:107]
v_perm_b32 v80, v41, v37, s45
v_perm_b32 v81, v49, v45, s45
v_perm_b32 v82, v57, v53, s45
v_perm_b32 v83, v65, v61, s45
v_mfma_f32_16x16x32_bf16 v[108:111], v[24:27], v[76:79], v[108:111]
v_perm_b32 v84, v42, v38, s44
v_perm_b32 v85, v50, v46, s44
v_perm_b32 v86, v58, v54, s44
v_perm_b32 v87, v66, v62, s44
v_mfma_f32_16x16x32_bf16 v[112:115], v[24:27], v[80:83], v[112:115]
v_perm_b32 v88, v42, v38, s45
v_perm_b32 v89, v50, v46, s45
v_perm_b32 v90, v58, v54, s45
v_perm_b32 v91, v66, v62, s45
v_mfma_f32_16x16x32_bf16 v[116:119], v[24:27], v[84:87], v[116:119]
v_perm_b32 v92, v43, v39, s44
v_perm_b32 v93, v51, v47, s44
v_perm_b32 v94, v59, v55, s44
v_perm_b32 v95, v67, v63, s44
v_mfma_f32_16x16x32_bf16 v[120:123], v[24:27], v[88:91], v[120:123]
v_perm_b32 v96, v43, v39, s45
v_perm_b32 v97, v51, v47, s45
v_perm_b32 v98, v59, v55, s45
v_perm_b32 v99, v67, v63, s45
v_mfma_f32_16x16x32_bf16 v[124:127], v[24:27], v[92:95], v[124:127]
buffer_load_dwordx4 v[36:39], v[8:9], s[16:19], s79 idxen offen
buffer_load_dwordx4 v[40:43], v[10:11], s[16:19], s79 idxen offen
v_mfma_f32_16x16x32_bf16 v[128:131], v[24:27], v[96:99], v[128:131]
buffer_load_dwordx4 v[44:47], v[12:13], s[16:19], s79 idxen offen
buffer_load_dwordx4 v[48:51], v[14:15], s[16:19], s79 idxen offen
buffer_load_dwordx4 v[52:55], v[16:17], s[16:19], s79 idxen offen
buffer_load_dwordx4 v[56:59], v[18:19], s[16:19], s79 idxen offen
buffer_load_dwordx4 v[60:63], v[20:21], s[16:19], s79 idxen offen
buffer_load_dwordx4 v[64:67], v[22:23], s[16:19], s79 idxen offen
s_sub_u32 s78, s78, 1
s_cmp_eq_u32 s78, 0
s_cselect_b32 s84, s73, 0x200
s_cselect_b32 s78, s48, s78
s_cselect_b32 s79, 0x100, s79
v_add_u32 v5, s84, v5
ds_read_u16 v8, v5 offset:0
ds_read_u16 v10, v5 offset:16
ds_read_u16 v12, v5 offset:32
ds_read_u16 v14, v5 offset:48
ds_read_u16 v16, v5 offset:256
ds_read_u16 v18, v5 offset:272
ds_read_u16 v20, v5 offset:288
ds_read_u16 v22, v5 offset:304
ds_read_u16_d16_hi v212, v1 offset:0
ds_read_u16_d16_hi v220, v2 offset:0
ds_read_u16_d16_hi v213, v1 offset:16
ds_read_u16_d16_hi v221, v2 offset:16
ds_read_u16_d16_hi v214, v1 offset:32
ds_read_u16_d16_hi v222, v2 offset:32
ds_read_u16_d16_hi v215, v1 offset:48
ds_read_u16_d16_hi v223, v2 offset:48
ds_read_u16_d16_hi v216, v1 offset:256
ds_read_u16_d16_hi v224, v2 offset:256
ds_read_u16_d16_hi v217, v1 offset:272
ds_read_u16_d16_hi v225, v2 offset:272
ds_read_u16_d16_hi v218, v1 offset:288
ds_read_u16_d16_hi v226, v2 offset:288
ds_read_u16_d16_hi v219, v1 offset:304
ds_read_u16_d16_hi v227, v2 offset:304
s_sub_u32 s72, s72, 1
s_cmp_eq_u32 s72, 0
s_cselect_b32 s84, s73, 0x200
s_cselect_b32 s72, s48, s72
v_add_u32 v1, s84, v1
v_and_b32 v7, s84, v3
v_add_u32 v2, v7, v2
main_kernel_v_after_4:
s_mov_b32 s76, s77
s_cmp_ge_u32 s76, s68
s_cbranch_scc1 main_kernel_endrange
main_kernel_v_resume:
s_cmp_eq_u32 s83, s62
s_cbranch_scc1 main_kernel_v_swp
main_kernel_v_swpr:
s_sub_u32 s84, s64, s76
s_min_u32 s84, s84, 32
s_lshl_b32 s84, s84, 6
v_add_u32 v7, s84, v6
ds_read_b128 v[32:35], v7
s_waitcnt lgkmcnt(1)
v_mul_f32 v212, v212, v220
v_mul_f32 v213, v213, v221
v_mul_f32 v214, v214, v222
v_mul_f32 v215, v215, v223
v_mul_f32 v216, v216, v224
v_mul_f32 v217, v217, v225
v_mul_f32 v218, v218, v226
v_mul_f32 v219, v219, v227
v_cvt_pk_bf16_f32 v24, v212, v213
v_cvt_pk_bf16_f32 v25, v214, v215
v_cvt_pk_bf16_f32 v26, v216, v217
v_cvt_pk_bf16_f32 v27, v218, v219
s_sub_u32 s83, s83, 1
s_cmp_eq_u32 s83, 0
s_cbranch_scc0 main_kernel_loop
s_branch main_kernel_v_final
main_kernel_v_swp:
s_cmp_ge_u32 s3, 4
s_cbranch_scc1 main_kernel_v_p0_7
s_setprio 1
s_branch main_kernel_v_p1_8
main_kernel_v_p0_7:
s_setprio 0
main_kernel_v_p1_8:
s_branch main_kernel_v_swpr
main_kernel_v_pb_3:
s_waitcnt lgkmcnt(0)
v_and_b32 v28, v24, v32
v_and_b32 v29, v25, v33
v_and_b32 v30, v26, v34
v_and_b32 v31, v27, v35
v_xor_b32 v24, v24, v28
v_xor_b32 v25, v25, v29
v_xor_b32 v26, v26, v30
v_xor_b32 v27, v27, v31
s_add_u32 s65, s65, 1
v_readlane_b32 s64, v252, s65
v_add_u32 v7, s80, v253
s_add_u32 s80, s80, 2080
s_mov_b32 s87, s76
s_waitcnt vmcnt(0)
v_perm_b32 v68, v40, v36, s44
v_perm_b32 v69, v48, v44, s44
v_perm_b32 v70, v56, v52, s44
v_perm_b32 v71, v64, v60, s44
v_perm_b32 v72, v40, v36, s45
v_perm_b32 v73, v48, v44, s45
v_perm_b32 v74, v56, v52, s45
v_perm_b32 v75, v64, v60, s45
v_mfma_f32_16x16x32_bf16 v[100:103], v[28:31], v[68:71], v[100:103]
v_perm_b32 v76, v41, v37, s44
v_perm_b32 v77, v49, v45, s44
v_perm_b32 v78, v57, v53, s44
v_perm_b32 v79, v65, v61, s44
v_mfma_f32_16x16x32_bf16 v[104:107], v[28:31], v[72:75], v[104:107]
v_perm_b32 v80, v41, v37, s45
v_perm_b32 v81, v49, v45, s45
v_perm_b32 v82, v57, v53, s45
v_perm_b32 v83, v65, v61, s45
v_mfma_f32_16x16x32_bf16 v[108:111], v[28:31], v[76:79], v[108:111]
v_perm_b32 v84, v42, v38, s44
v_perm_b32 v85, v50, v46, s44
v_perm_b32 v86, v58, v54, s44
v_perm_b32 v87, v66, v62, s44
v_mfma_f32_16x16x32_bf16 v[112:115], v[28:31], v[80:83], v[112:115]
v_perm_b32 v88, v42, v38, s45
v_perm_b32 v89, v50, v46, s45
v_perm_b32 v90, v58, v54, s45
v_perm_b32 v91, v66, v62, s45
v_mfma_f32_16x16x32_bf16 v[116:119], v[28:31], v[84:87], v[116:119]
v_perm_b32 v92, v43, v39, s44
v_perm_b32 v93, v51, v47, s44
v_perm_b32 v94, v59, v55, s44
v_perm_b32 v95, v67, v63, s44
v_mfma_f32_16x16x32_bf16 v[120:123], v[28:31], v[88:91], v[120:123]
v_perm_b32 v96, v43, v39, s45
v_perm_b32 v97, v51, v47, s45
v_perm_b32 v98, v59, v55, s45
v_perm_b32 v99, v67, v63, s45
v_mfma_f32_16x16x32_bf16 v[124:127], v[28:31], v[92:95], v[124:127]
buffer_load_dwordx4 v[36:39], v[8:9], s[16:19], s79 idxen offen
buffer_load_dwordx4 v[40:43], v[10:11], s[16:19], s79 idxen offen
v_mfma_f32_16x16x32_bf16 v[128:131], v[28:31], v[96:99], v[128:131]
buffer_load_dwordx4 v[44:47], v[12:13], s[16:19], s79 idxen offen
buffer_load_dwordx4 v[48:51], v[14:15], s[16:19], s79 idxen offen
buffer_load_dwordx4 v[52:55], v[16:17], s[16:19], s79 idxen offen
buffer_load_dwordx4 v[56:59], v[18:19], s[16:19], s79 idxen offen
buffer_load_dwordx4 v[60:63], v[20:21], s[16:19], s79 idxen offen
buffer_load_dwordx4 v[64:67], v[22:23], s[16:19], s79 idxen offen
s_sub_u32 s78, s78, 1
s_cmp_eq_u32 s78, 0
s_cselect_b32 s84, s73, 0x200
s_cselect_b32 s78, s48, s78
s_cselect_b32 s79, 0x100, s79
v_add_u32 v5, s84, v5
ds_read_u16 v8, v5 offset:0
ds_read_u16 v10, v5 offset:16
ds_read_u16 v12, v5 offset:32
ds_read_u16 v14, v5 offset:48
ds_read_u16 v16, v5 offset:256
ds_read_u16 v18, v5 offset:272
ds_read_u16 v20, v5 offset:288
ds_read_u16 v22, v5 offset:304
ds_read_u16_d16_hi v212, v1 offset:0
ds_read_u16_d16_hi v220, v2 offset:0
ds_read_u16_d16_hi v213, v1 offset:16
ds_read_u16_d16_hi v221, v2 offset:16
ds_read_u16_d16_hi v214, v1 offset:32
ds_read_u16_d16_hi v222, v2 offset:32
ds_read_u16_d16_hi v215, v1 offset:48
ds_read_u16_d16_hi v223, v2 offset:48
ds_read_u16_d16_hi v216, v1 offset:256
ds_read_u16_d16_hi v224, v2 offset:256
ds_read_u16_d16_hi v217, v1 offset:272
ds_read_u16_d16_hi v225, v2 offset:272
ds_read_u16_d16_hi v218, v1 offset:288
ds_read_u16_d16_hi v226, v2 offset:288
ds_read_u16_d16_hi v219, v1 offset:304
ds_read_u16_d16_hi v227, v2 offset:304
s_sub_u32 s72, s72, 1
s_cmp_eq_u32 s72, 0
s_cselect_b32 s84, s73, 0x200
s_cselect_b32 s72, s48, s72
v_add_u32 v1, s84, v1
v_and_b32 v7, s84, v3
v_add_u32 v2, v7, v2
s_sub_u32 s84, s80, 2080
v_add_u32 v7, s84, v253
s_cmp_le_u32 s64, s77
s_cbranch_scc1 main_kernel_v_more_5
main_kernel_v_pbt_6:
v_mul_f32 v228, v100, v132
v_fmac_f32 v228, v101, v133
v_fmac_f32 v228, v102, v134
v_fmac_f32 v228, v103, v135
v_mfma_f32_16x16x32_bf16 v[100:103], v[24:27], v[68:71], 0
v_mul_f32 v229, v104, v136
v_fmac_f32 v229, v105, v137
v_fmac_f32 v229, v106, v138
v_fmac_f32 v229, v107, v139
v_mfma_f32_16x16x32_bf16 v[104:107], v[24:27], v[72:75], 0
v_mul_f32 v230, v108, v140
v_fmac_f32 v230, v109, v141
v_fmac_f32 v230, v110, v142
v_fmac_f32 v230, v111, v143
v_mfma_f32_16x16x32_bf16 v[108:111], v[24:27], v[76:79], 0
v_mul_f32 v231, v112, v144
v_fmac_f32 v231, v113, v145
v_fmac_f32 v231, v114, v146
v_fmac_f32 v231, v115, v147
v_mfma_f32_16x16x32_bf16 v[112:115], v[24:27], v[80:83], 0
v_mul_f32 v232, v116, v148
v_fmac_f32 v232, v117, v149
v_fmac_f32 v232, v118, v150
v_fmac_f32 v232, v119, v151
v_mfma_f32_16x16x32_bf16 v[116:119], v[24:27], v[84:87], 0
v_mul_f32 v233, v120, v152
v_fmac_f32 v233, v121, v153
v_fmac_f32 v233, v122, v154
v_fmac_f32 v233, v123, v155
v_mfma_f32_16x16x32_bf16 v[120:123], v[24:27], v[88:91], 0
v_mul_f32 v234, v124, v156
v_fmac_f32 v234, v125, v157
v_fmac_f32 v234, v126, v158
v_fmac_f32 v234, v127, v159
v_mfma_f32_16x16x32_bf16 v[124:127], v[24:27], v[92:95], 0
v_mul_f32 v235, v128, v160
v_fmac_f32 v235, v129, v161
v_fmac_f32 v235, v130, v162
v_fmac_f32 v235, v131, v163
v_mfma_f32_16x16x32_bf16 v[128:131], v[24:27], v[96:99], 0
v_cvt_pk_bf16_f32 v228, v228, v229
v_cvt_pk_bf16_f32 v229, v230, v231
v_cvt_pk_bf16_f32 v230, v232, v233
v_cvt_pk_bf16_f32 v231, v234, v235
ds_write_b128 v7, v[228:231]
s_branch main_kernel_v_after_4
main_kernel_v_more_5:
s_nop 7
v_mul_f32 v228, v100, v132
v_fmac_f32 v228, v101, v133
v_fmac_f32 v228, v102, v134
v_fmac_f32 v228, v103, v135
v_mul_f32 v229, v104, v136
v_fmac_f32 v229, v105, v137
v_fmac_f32 v229, v106, v138
v_fmac_f32 v229, v107, v139
v_mul_f32 v230, v108, v140
v_fmac_f32 v230, v109, v141
v_fmac_f32 v230, v110, v142
v_fmac_f32 v230, v111, v143
v_mul_f32 v231, v112, v144
v_fmac_f32 v231, v113, v145
v_fmac_f32 v231, v114, v146
v_fmac_f32 v231, v115, v147
v_mul_f32 v232, v116, v148
v_fmac_f32 v232, v117, v149
v_fmac_f32 v232, v118, v150
v_fmac_f32 v232, v119, v151
v_mul_f32 v233, v120, v152
v_fmac_f32 v233, v121, v153
v_fmac_f32 v233, v122, v154
v_fmac_f32 v233, v123, v155
v_mul_f32 v234, v124, v156
v_fmac_f32 v234, v125, v157
v_fmac_f32 v234, v126, v158
v_fmac_f32 v234, v127, v159
v_mul_f32 v235, v128, v160
v_fmac_f32 v235, v129, v161
v_fmac_f32 v235, v130, v162
v_fmac_f32 v235, v131, v163
v_cvt_pk_bf16_f32 v228, v228, v229
v_cvt_pk_bf16_f32 v229, v230, v231
v_cvt_pk_bf16_f32 v230, v232, v233
v_cvt_pk_bf16_f32 v231, v234, v235
ds_write_b128 v7, v[228:231]
s_sub_u32 s84, s64, s76
s_lshl_b32 s84, s84, 6
v_add_u32 v7, s84, v6
s_waitcnt lgkmcnt(0)
ds_read_b128 v[32:35], v7
s_add_u32 s65, s65, 1
v_readlane_b32 s64, v252, s65
v_add_u32 v7, s80, v253
s_add_u32 s80, s80, 2080
s_waitcnt lgkmcnt(0)
v_and_b32 v28, v24, v32
v_and_b32 v29, v25, v33
v_and_b32 v30, v26, v34
v_and_b32 v31, v27, v35
v_xor_b32 v24, v24, v28
v_xor_b32 v25, v25, v29
v_xor_b32 v26, v26, v30
v_xor_b32 v27, v27, v31
s_nop 1
v_mfma_f32_16x16x32_bf16 v[100:103], v[28:31], v[68:71], 0
v_mfma_f32_16x16x32_bf16 v[104:107], v[28:31], v[72:75], 0
v_mfma_f32_16x16x32_bf16 v[108:111], v[28:31], v[76:79], 0
v_mfma_f32_16x16x32_bf16 v[112:115], v[28:31], v[80:83], 0
v_mfma_f32_16x16x32_bf16 v[116:119], v[28:31], v[84:87], 0
v_mfma_f32_16x16x32_bf16 v[120:123], v[28:31], v[88:91], 0
v_mfma_f32_16x16x32_bf16 v[124:127], v[28:31], v[92:95], 0
v_mfma_f32_16x16x32_bf16 v[128:131], v[28:31], v[96:99], 0
s_cmp_le_u32 s64, s77
s_cbranch_scc1 main_kernel_v_more_5
s_nop 7
s_branch main_kernel_v_pbt_6
main_kernel_v_final:
s_add_u32 s77, s76, 32
s_cmp_le_u32 s64, s77
s_cbranch_scc1 main_kernel_f_pb_9
s_waitcnt vmcnt(0)
v_perm_b32 v68, v40, v36, s44
v_perm_b32 v69, v48, v44, s44
v_perm_b32 v70, v56, v52, s44
v_perm_b32 v71, v64, v60, s44
v_perm_b32 v72, v40, v36, s45
v_perm_b32 v73, v48, v44, s45
v_perm_b32 v74, v56, v52, s45
v_perm_b32 v75, v64, v60, s45
v_mfma_f32_16x16x32_bf16 v[100:103], v[24:27], v[68:71], v[100:103]
v_perm_b32 v76, v41, v37, s44
v_perm_b32 v77, v49, v45, s44
v_perm_b32 v78, v57, v53, s44
v_perm_b32 v79, v65, v61, s44
v_mfma_f32_16x16x32_bf16 v[104:107], v[24:27], v[72:75], v[104:107]
v_perm_b32 v80, v41, v37, s45
v_perm_b32 v81, v49, v45, s45
v_perm_b32 v82, v57, v53, s45
v_perm_b32 v83, v65, v61, s45
v_mfma_f32_16x16x32_bf16 v[108:111], v[24:27], v[76:79], v[108:111]
v_perm_b32 v84, v42, v38, s44
v_perm_b32 v85, v50, v46, s44
v_perm_b32 v86, v58, v54, s44
v_perm_b32 v87, v66, v62, s44
v_mfma_f32_16x16x32_bf16 v[112:115], v[24:27], v[80:83], v[112:115]
v_perm_b32 v88, v42, v38, s45
v_perm_b32 v89, v50, v46, s45
v_perm_b32 v90, v58, v54, s45
v_perm_b32 v91, v66, v62, s45
v_mfma_f32_16x16x32_bf16 v[116:119], v[24:27], v[84:87], v[116:119]
v_perm_b32 v92, v43, v39, s44
v_perm_b32 v93, v51, v47, s44
v_perm_b32 v94, v59, v55, s44
v_perm_b32 v95, v67, v63, s44
v_mfma_f32_16x16x32_bf16 v[120:123], v[24:27], v[88:91], v[120:123]
v_perm_b32 v96, v43, v39, s45
v_perm_b32 v97, v51, v47, s45
v_perm_b32 v98, v59, v55, s45
v_perm_b32 v99, v67, v63, s45
v_mfma_f32_16x16x32_bf16 v[124:127], v[24:27], v[92:95], v[124:127]
s_nop 1
v_mfma_f32_16x16x32_bf16 v[128:131], v[24:27], v[96:99], v[128:131]
main_kernel_f_after_10:
s_mov_b32 s76, s77
s_cmp_ge_u32 s76, s68
s_cbranch_scc1 main_kernel_endrange
s_branch main_kernel_endrange
main_kernel_f_pb_9:
s_waitcnt lgkmcnt(0)
v_and_b32 v28, v24, v32
v_and_b32 v29, v25, v33
v_and_b32 v30, v26, v34
v_and_b32 v31, v27, v35
v_xor_b32 v24, v24, v28
v_xor_b32 v25, v25, v29
v_xor_b32 v26, v26, v30
v_xor_b32 v27, v27, v31
s_add_u32 s65, s65, 1
v_readlane_b32 s64, v252, s65
v_add_u32 v7, s80, v253
s_add_u32 s80, s80, 2080
s_mov_b32 s87, s76
s_waitcnt vmcnt(0)
v_perm_b32 v68, v40, v36, s44
v_perm_b32 v69, v48, v44, s44
v_perm_b32 v70, v56, v52, s44
v_perm_b32 v71, v64, v60, s44
v_perm_b32 v72, v40, v36, s45
v_perm_b32 v73, v48, v44, s45
v_perm_b32 v74, v56, v52, s45
v_perm_b32 v75, v64, v60, s45
v_mfma_f32_16x16x32_bf16 v[100:103], v[28:31], v[68:71], v[100:103]
v_perm_b32 v76, v41, v37, s44
v_perm_b32 v77, v49, v45, s44
v_perm_b32 v78, v57, v53, s44
v_perm_b32 v79, v65, v61, s44
v_mfma_f32_16x16x32_bf16 v[104:107], v[28:31], v[72:75], v[104:107]
v_perm_b32 v80, v41, v37, s45
v_perm_b32 v81, v49, v45, s45
v_perm_b32 v82, v57, v53, s45
v_perm_b32 v83, v65, v61, s45
v_mfma_f32_16x16x32_bf16 v[108:111], v[28:31], v[76:79], v[108:111]
v_perm_b32 v84, v42, v38, s44
v_perm_b32 v85, v50, v46, s44
v_perm_b32 v86, v58, v54, s44
v_perm_b32 v87, v66, v62, s44
v_mfma_f32_16x16x32_bf16 v[112:115], v[28:31], v[80:83], v[112:115]
v_perm_b32 v88, v42, v38, s45
v_perm_b32 v89, v50, v46, s45
v_perm_b32 v90, v58, v54, s45
v_perm_b32 v91, v66, v62, s45
v_mfma_f32_16x16x32_bf16 v[116:119], v[28:31], v[84:87], v[116:119]
v_perm_b32 v92, v43, v39, s44
v_perm_b32 v93, v51, v47, s44
v_perm_b32 v94, v59, v55, s44
v_perm_b32 v95, v67, v63, s44
v_mfma_f32_16x16x32_bf16 v[120:123], v[28:31], v[88:91], v[120:123]
v_perm_b32 v96, v43, v39, s45
v_perm_b32 v97, v51, v47, s45
v_perm_b32 v98, v59, v55, s45
v_perm_b32 v99, v67, v63, s45
v_mfma_f32_16x16x32_bf16 v[124:127], v[28:31], v[92:95], v[124:127]
s_nop 1
v_mfma_f32_16x16x32_bf16 v[128:131], v[28:31], v[96:99], v[128:131]
s_sub_u32 s84, s80, 2080
v_add_u32 v7, s84, v253
s_cmp_le_u32 s64, s77
s_cbranch_scc1 main_kernel_f_more_11
main_kernel_f_pbt_12:
v_mul_f32 v228, v100, v132
v_fmac_f32 v228, v101, v133
v_fmac_f32 v228, v102, v134
v_fmac_f32 v228, v103, v135
v_mfma_f32_16x16x32_bf16 v[100:103], v[24:27], v[68:71], 0
v_mul_f32 v229, v104, v136
v_fmac_f32 v229, v105, v137
v_fmac_f32 v229, v106, v138
v_fmac_f32 v229, v107, v139
v_mfma_f32_16x16x32_bf16 v[104:107], v[24:27], v[72:75], 0
v_mul_f32 v230, v108, v140
v_fmac_f32 v230, v109, v141
v_fmac_f32 v230, v110, v142
v_fmac_f32 v230, v111, v143
v_mfma_f32_16x16x32_bf16 v[108:111], v[24:27], v[76:79], 0
v_mul_f32 v231, v112, v144
v_fmac_f32 v231, v113, v145
v_fmac_f32 v231, v114, v146
v_fmac_f32 v231, v115, v147
v_mfma_f32_16x16x32_bf16 v[112:115], v[24:27], v[80:83], 0
v_mul_f32 v232, v116, v148
v_fmac_f32 v232, v117, v149
v_fmac_f32 v232, v118, v150
v_fmac_f32 v232, v119, v151
v_mfma_f32_16x16x32_bf16 v[116:119], v[24:27], v[84:87], 0
v_mul_f32 v233, v120, v152
v_fmac_f32 v233, v121, v153
v_fmac_f32 v233, v122, v154
v_fmac_f32 v233, v123, v155
v_mfma_f32_16x16x32_bf16 v[120:123], v[24:27], v[88:91], 0
v_mul_f32 v234, v124, v156
v_fmac_f32 v234, v125, v157
v_fmac_f32 v234, v126, v158
v_fmac_f32 v234, v127, v159
v_mfma_f32_16x16x32_bf16 v[124:127], v[24:27], v[92:95], 0
v_mul_f32 v235, v128, v160
v_fmac_f32 v235, v129, v161
v_fmac_f32 v235, v130, v162
v_fmac_f32 v235, v131, v163
v_mfma_f32_16x16x32_bf16 v[128:131], v[24:27], v[96:99], 0
v_cvt_pk_bf16_f32 v228, v228, v229
v_cvt_pk_bf16_f32 v229, v230, v231
v_cvt_pk_bf16_f32 v230, v232, v233
v_cvt_pk_bf16_f32 v231, v234, v235
ds_write_b128 v7, v[228:231]
s_branch main_kernel_f_after_10
main_kernel_f_more_11:
s_nop 7
v_mul_f32 v228, v100, v132
v_fmac_f32 v228, v101, v133
v_fmac_f32 v228, v102, v134
v_fmac_f32 v228, v103, v135
v_mul_f32 v229, v104, v136
v_fmac_f32 v229, v105, v137
v_fmac_f32 v229, v106, v138
v_fmac_f32 v229, v107, v139
v_mul_f32 v230, v108, v140
v_fmac_f32 v230, v109, v141
v_fmac_f32 v230, v110, v142
v_fmac_f32 v230, v111, v143
v_mul_f32 v231, v112, v144
v_fmac_f32 v231, v113, v145
v_fmac_f32 v231, v114, v146
v_fmac_f32 v231, v115, v147
v_mul_f32 v232, v116, v148
v_fmac_f32 v232, v117, v149
v_fmac_f32 v232, v118, v150
v_fmac_f32 v232, v119, v151
v_mul_f32 v233, v120, v152
v_fmac_f32 v233, v121, v153
v_fmac_f32 v233, v122, v154
v_fmac_f32 v233, v123, v155
v_mul_f32 v234, v124, v156
v_fmac_f32 v234, v125, v157
v_fmac_f32 v234, v126, v158
v_fmac_f32 v234, v127, v159
v_mul_f32 v235, v128, v160
v_fmac_f32 v235, v129, v161
v_fmac_f32 v235, v130, v162
v_fmac_f32 v235, v131, v163
v_cvt_pk_bf16_f32 v228, v228, v229
v_cvt_pk_bf16_f32 v229, v230, v231
v_cvt_pk_bf16_f32 v230, v232, v233
v_cvt_pk_bf16_f32 v231, v234, v235
ds_write_b128 v7, v[228:231]
s_sub_u32 s84, s64, s76
s_lshl_b32 s84, s84, 6
v_add_u32 v7, s84, v6
s_waitcnt lgkmcnt(0)
ds_read_b128 v[32:35], v7
s_add_u32 s65, s65, 1
v_readlane_b32 s64, v252, s65
v_add_u32 v7, s80, v253
s_add_u32 s80, s80, 2080
s_waitcnt lgkmcnt(0)
v_and_b32 v28, v24, v32
v_and_b32 v29, v25, v33
v_and_b32 v30, v26, v34
v_and_b32 v31, v27, v35
v_xor_b32 v24, v24, v28
v_xor_b32 v25, v25, v29
v_xor_b32 v26, v26, v30
v_xor_b32 v27, v27, v31
s_nop 1
v_mfma_f32_16x16x32_bf16 v[100:103], v[28:31], v[68:71], 0
v_mfma_f32_16x16x32_bf16 v[104:107], v[28:31], v[72:75], 0
v_mfma_f32_16x16x32_bf16 v[108:111], v[28:31], v[76:79], 0
v_mfma_f32_16x16x32_bf16 v[112:115], v[28:31], v[80:83], 0
v_mfma_f32_16x16x32_bf16 v[116:119], v[28:31], v[84:87], 0
v_mfma_f32_16x16x32_bf16 v[120:123], v[28:31], v[88:91], 0
v_mfma_f32_16x16x32_bf16 v[124:127], v[28:31], v[92:95], 0
v_mfma_f32_16x16x32_bf16 v[128:131], v[28:31], v[96:99], 0
s_cmp_le_u32 s64, s77
s_cbranch_scc1 main_kernel_f_more_11
s_nop 7
s_branch main_kernel_f_pbt_12
main_kernel_endrange:
s_cmp_eq_u32 s64, 0x7fffffff
s_cbranch_scc1 main_kernel_nopart_13
s_nop 7
v_mul_f32 v228, v100, v132
v_fmac_f32 v228, v101, v133
v_fmac_f32 v228, v102, v134
v_fmac_f32 v228, v103, v135
v_mul_f32 v229, v104, v136
v_fmac_f32 v229, v105, v137
v_fmac_f32 v229, v106, v138
v_fmac_f32 v229, v107, v139
v_mul_f32 v230, v108, v140
v_fmac_f32 v230, v109, v141
v_fmac_f32 v230, v110, v142
v_fmac_f32 v230, v111, v143
v_mul_f32 v231, v112, v144
v_fmac_f32 v231, v113, v145
v_fmac_f32 v231, v114, v146
v_fmac_f32 v231, v115, v147
v_mul_f32 v232, v116, v148
v_fmac_f32 v232, v117, v149
v_fmac_f32 v232, v118, v150
v_fmac_f32 v232, v119, v151
v_mul_f32 v233, v120, v152
v_fmac_f32 v233, v121, v153
v_fmac_f32 v233, v122, v154
v_fmac_f32 v233, v123, v155
v_mul_f32 v234, v124, v156
v_fmac_f32 v234, v125, v157
v_fmac_f32 v234, v126, v158
v_fmac_f32 v234, v127, v159
v_mul_f32 v235, v128, v160
v_fmac_f32 v235, v129, v161
v_fmac_f32 v235, v130, v162
v_fmac_f32 v235, v131, v163
s_cmp_lg_u32 s82, 0
s_cbranch_scc1 main_kernel_ptb_14
v_mov_b32 v236, v228
v_mov_b32 v237, v229
v_mov_b32 v238, v230
v_mov_b32 v239, v231
v_mov_b32 v240, v232
v_mov_b32 v241, v233
v_mov_b32 v242, v234
v_mov_b32 v243, v235
s_mov_b32 s69, 1
s_mul_i32 s70, s65, 2080
s_branch main_kernel_ptj_15
main_kernel_ptb_14:
v_mov_b32 v244, v228
v_mov_b32 v245, v229
v_mov_b32 v246, v230
v_mov_b32 v247, v231
v_mov_b32 v248, v232
v_mov_b32 v249, v233
v_mov_b32 v250, v234
v_mov_b32 v251, v235
s_mov_b32 s50, 1
s_mul_i32 s51, s65, 2080
main_kernel_ptj_15:
main_kernel_nopart_13:
s_cmp_lg_u32 s82, 0
s_cbranch_scc1 main_kernel_endmain
s_mov_b32 s82, 1
s_mov_b32 s76, s46
s_mov_b32 s68, s47
s_mov_b32 s65, s49
v_readlane_b32 s64, v252, s65
s_mul_i32 s80, s65, 2080
s_add_u32 s80, s80, 1024
v_bfe_u32 v86, v0, 3, 3
v_lshlrev_b32 v86, 2, v86
s_mov_b32 s84, 474072115
v_lshrrev_b32 v86, v86, s84
v_bfe_u32 v85, v86, 3, 1
v_and_b32 v86, 7, v86
v_lshlrev_b32 v86, 7, v86
v_and_b32 v84, 7, v0
v_lshl_add_u32 v84, v84, 4, v86
s_mov_b32 s84, 0x80008000
v_mul_lo_u32 v85, v85, s84
ds_read_b128 v[68:71], v84 offset:2816
ds_read_b128 v[72:75], v84 offset:3456
ds_read_b128 v[76:79], v84 offset:4096
ds_read_b128 v[80:83], v84 offset:4736
s_waitcnt lgkmcnt(3)
v_xor_b32 v68, v68, v85
v_xor_b32 v69, v69, v85
v_xor_b32 v70, v70, v85
v_xor_b32 v71, v71, v85
v_lshlrev_b32 v132, 16, v68
v_and_b32 v136, 0xffff0000, v68
v_lshlrev_b32 v140, 16, v69
v_and_b32 v144, 0xffff0000, v69
v_lshlrev_b32 v148, 16, v70
v_and_b32 v152, 0xffff0000, v70
v_lshlrev_b32 v156, 16, v71
v_and_b32 v160, 0xffff0000, v71
s_waitcnt lgkmcnt(2)
v_xor_b32 v72, v72, v85
v_xor_b32 v73, v73, v85
v_xor_b32 v74, v74, v85
v_xor_b32 v75, v75, v85
v_lshlrev_b32 v133, 16, v72
v_and_b32 v137, 0xffff0000, v72
v_lshlrev_b32 v141, 16, v73
v_and_b32 v145, 0xffff0000, v73
v_lshlrev_b32 v149, 16, v74
v_and_b32 v153, 0xffff0000, v74
v_lshlrev_b32 v157, 16, v75
v_and_b32 v161, 0xffff0000, v75
s_waitcnt lgkmcnt(1)
v_xor_b32 v76, v76, v85
v_xor_b32 v77, v77, v85
v_xor_b32 v78, v78, v85
v_xor_b32 v79, v79, v85
v_lshlrev_b32 v134, 16, v76
v_and_b32 v138, 0xffff0000, v76
v_lshlrev_b32 v142, 16, v77
v_and_b32 v146, 0xffff0000, v77
v_lshlrev_b32 v150, 16, v78
v_and_b32 v154, 0xffff0000, v78
v_lshlrev_b32 v158, 16, v79
v_and_b32 v162, 0xffff0000, v79
s_waitcnt lgkmcnt(0)
v_xor_b32 v80, v80, v85
v_xor_b32 v81, v81, v85
v_xor_b32 v82, v82, v85
v_xor_b32 v83, v83, v85
v_lshlrev_b32 v135, 16, v80
v_and_b32 v139, 0xffff0000, v80
v_lshlrev_b32 v143, 16, v81
v_and_b32 v147, 0xffff0000, v81
v_lshlrev_b32 v151, 16, v82
v_and_b32 v155, 0xffff0000, v82
v_lshlrev_b32 v159, 16, v83
v_and_b32 v163, 0xffff0000, v83
v_mov_b32 v100, 0
v_mov_b32 v101, 0
v_mov_b32 v102, 0
v_mov_b32 v103, 0
v_mov_b32 v104, 0
v_mov_b32 v105, 0
v_mov_b32 v106, 0
v_mov_b32 v107, 0
v_mov_b32 v108, 0
v_mov_b32 v109, 0
v_mov_b32 v110, 0
v_mov_b32 v111, 0
v_mov_b32 v112, 0
v_mov_b32 v113, 0
v_mov_b32 v114, 0
v_mov_b32 v115, 0
v_mov_b32 v116, 0
v_mov_b32 v117, 0
v_mov_b32 v118, 0
v_mov_b32 v119, 0
v_mov_b32 v120, 0
v_mov_b32 v121, 0
v_mov_b32 v122, 0
v_mov_b32 v123, 0
v_mov_b32 v124, 0
v_mov_b32 v125, 0
v_mov_b32 v126, 0
v_mov_b32 v127, 0
v_mov_b32 v128, 0
v_mov_b32 v129, 0
v_mov_b32 v130, 0
v_mov_b32 v131, 0
s_branch main_kernel_v_resume
main_kernel_endmain:
s_setprio 0
s_waitcnt lgkmcnt(0)
v_add_u32 v14, s70, v253
v_add_u32 v15, s51, v253
v_bfe_u32 v1, v0, 4, 2
v_and_b32 v2, 15, v0
s_lshr_b32 s59, s3, 1
s_and_b32 s60, s3, 1
s_movk_i32 s84, 2080
v_mul_u32_u24 v12, s84, v2
v_lshl_add_u32 v12, v1, 4, v12
v_add_u32 v12, 52992, v12
s_mov_b32 s88, 3191994960
s_mov_b32 s89, 1774442370
s_lshl_b32 s90, s59, 4
s_lshr_b64 s[88:89], s[88:89], s90
s_bfe_u32 s90, s88, 262144
s_lshl_b32 s90, s90, 7
v_add_u32 v8, s90, v12
v_add_u32 v16, 66560, v8
s_bfe_u32 s90, s88, 262148
s_lshl_b32 s90, s90, 7
v_add_u32 v9, s90, v12
v_add_u32 v17, 66560, v9
s_bfe_u32 s90, s88, 262152
s_lshl_b32 s90, s90, 7
v_add_u32 v10, s90, v12
v_add_u32 v18, 66560, v10
s_bfe_u32 s90, s88, 262156
s_lshl_b32 s90, s90, 7
v_add_u32 v11, s90, v12
v_add_u32 v19, 66560, v11
s_mul_i32 s58, s95, 49152
s_add_u32 s58, s58, 16777216
v_mul_u32_u24 v13, 96, v0
s_movk_i32 s84, 272
v_mul_u32_u24 v20, s84, v2
v_lshl_add_u32 v20, v1, 5, v20
s_lshl_b32 s84, s60, 7
s_add_u32 s84, s84, 136192
v_add_u32 v20, s84, v20
s_mul_i32 s88, s95, 625
s_add_u32 s89, s88, 15
s_lshr_b32 s89, s89, 4
s_add_u32 s88, s88, 640
s_lshr_b32 s88, s88, 4
s_sub_u32 s88, s88, s89
s_sub_u32 s57, s88, 32
s_lshl_b32 s89, s89, 9
s_lshl_b32 s90, s59, 7
s_add_u32 s89, s89, s90
s_lshl_b32 s90, s60, 6
s_add_u32 s56, s89, s90
v_lshlrev_b32 v21, 9, v2
v_lshl_add_u32 v21, v1, 4, v21
v_add_u32 v22, 8192, v21
v_add_u32 v23, 16384, v21
s_mov_b32 s61, 0xbfb8aa3b
s_nop 7
s_cmp_eq_u32 s92, 0
s_cbranch_scc1 main_kernel_oz_16
s_cmp_eq_u32 s93, 0
s_cbranch_scc1 main_kernel_oz_16
buffer_load_dwordx4 v[100:103], v13, s[20:23], s58 offen offset:0 sc1
buffer_load_dwordx4 v[104:107], v13, s[20:23], s58 offen offset:16 sc1
buffer_load_dwordx4 v[108:111], v13, s[20:23], s58 offen offset:32 sc1
buffer_load_dwordx4 v[112:115], v13, s[20:23], s58 offen offset:48 sc1
buffer_load_dwordx4 v[116:119], v13, s[20:23], s58 offen offset:64 sc1
buffer_load_dwordx4 v[120:123], v13, s[20:23], s58 offen offset:80 sc1
s_waitcnt vmcnt(0)
s_branch main_kernel_oj_17
main_kernel_oz_16:
v_mov_b32 v100, 0
v_mov_b32 v101, 0
v_mov_b32 v102, 0
v_mov_b32 v103, 0
v_mov_b32 v104, 0
v_mov_b32 v105, 0
v_mov_b32 v106, 0
v_mov_b32 v107, 0
v_mov_b32 v108, 0
v_mov_b32 v109, 0
v_mov_b32 v110, 0
v_mov_b32 v111, 0
v_mov_b32 v112, 0
v_mov_b32 v113, 0
v_mov_b32 v114, 0
v_mov_b32 v115, 0
v_mov_b32 v116, 0
v_mov_b32 v117, 0
v_mov_b32 v118, 0
v_mov_b32 v119, 0
v_mov_b32 v120, 0
v_mov_b32 v121, 0
v_mov_b32 v122, 0
v_mov_b32 v123, 0
main_kernel_oj_17:
s_mov_b32 s90, 0
s_waitcnt vmcnt(0) lgkmcnt(0)
s_barrier
main_kernel_rl_18:
s_cmp_eq_u32 s53, s90
s_cselect_b32 s88, s69, 0
s_cmp_eq_u32 s88, 0
s_cbranch_scc1 main_kernel_rs_20
ds_read_b128 v[36:39], v14 offset:0
main_kernel_rs_20:
s_cmp_eq_u32 s54, s90
s_cselect_b32 s89, s50, 0
s_cmp_eq_u32 s89, 0
s_cbranch_scc1 main_kernel_rs_21
ds_read_b128 v[40:43], v15 offset:1024
main_kernel_rs_21:
s_waitcnt lgkmcnt(0)
s_cmp_eq_u32 s88, 0
s_cbranch_scc1 main_kernel_rs_22
v_lshlrev_b32 v228, 16, v36
v_and_b32 v229, 0xffff0000, v36
v_lshlrev_b32 v230, 16, v37
v_and_b32 v231, 0xffff0000, v37
v_lshlrev_b32 v232, 16, v38
v_and_b32 v233, 0xffff0000, v38
v_lshlrev_b32 v234, 16, v39
v_and_b32 v235, 0xffff0000, v39
v_add_f32 v228, v228, v236
v_add_f32 v229, v229, v237
v_add_f32 v230, v230, v238
v_add_f32 v231, v231, v239
v_add_f32 v232, v232, v240
v_add_f32 v233, v233, v241
v_add_f32 v234, v234, v242
v_add_f32 v235, v235, v243
v_cvt_pk_bf16_f32 v36, v228, v229
v_cvt_pk_bf16_f32 v37, v230, v231
v_cvt_pk_bf16_f32 v38, v232, v233
v_cvt_pk_bf16_f32 v39, v234, v235
ds_write_b128 v14, v[36:39] offset:0
main_kernel_rs_22:
s_cmp_eq_u32 s89, 0
s_cbranch_scc1 main_kernel_rs_23
v_lshlrev_b32 v228, 16, v40
v_and_b32 v229, 0xffff0000, v40
v_lshlrev_b32 v230, 16, v41
v_and_b32 v231, 0xffff0000, v41
v_lshlrev_b32 v232, 16, v42
v_and_b32 v233, 0xffff0000, v42
v_lshlrev_b32 v234, 16, v43
v_and_b32 v235, 0xffff0000, v43
v_add_f32 v228, v228, v244
v_add_f32 v229, v229, v245
v_add_f32 v230, v230, v246
v_add_f32 v231, v231, v247
v_add_f32 v232, v232, v248
v_add_f32 v233, v233, v249
v_add_f32 v234, v234, v250
v_add_f32 v235, v235, v251
v_cvt_pk_bf16_f32 v40, v228, v229
v_cvt_pk_bf16_f32 v41, v230, v231
v_cvt_pk_bf16_f32 v42, v232, v233
v_cvt_pk_bf16_f32 v43, v234, v235
ds_write_b128 v15, v[40:43] offset:1024
main_kernel_rs_23:
s_cmp_eq_u32 s52, 0
s_cbranch_scc1 main_kernel_rd_19
s_lshl_b32 s91, s52, 1
s_and_b32 s52, s52, s91
s_add_u32 s90, s90, 1
s_waitcnt lgkmcnt(0)
s_barrier
s_branch main_kernel_rl_18
main_kernel_rd_19:
s_waitcnt lgkmcnt(0)
s_barrier
s_cmp_lg_u32 s59, 0
s_cbranch_scc1 main_kernel_plain_24
s_cmp_eq_u32 s92, 0
s_cbranch_scc1 main_kernel_plain_24_g
s_cmp_lt_u32 s93, 255
s_cbranch_scc1 main_kernel_plain_24
main_kernel_plain_24_g:
ds_read_b128 v[36:39], v8 offset:0
ds_read_b128 v[40:43], v8 offset:64
ds_read_b128 v[44:47], v9 offset:0
ds_read_b128 v[48:51], v9 offset:64
ds_read_b128 v[52:55], v10 offset:0
ds_read_b128 v[56:59], v10 offset:64
ds_read_b128 v[60:63], v11 offset:0
ds_read_b128 v[64:67], v11 offset:64
ds_read_b128 v[68:71], v8 offset:33280
ds_read_b128 v[72:75], v8 offset:33344
ds_read_b128 v[76:79], v9 offset:33280
ds_read_b128 v[80:83], v9 offset:33344
ds_read_b128 v[84:87], v10 offset:33280
ds_read_b128 v[88:91], v10 offset:33344
ds_read_b128 v[92:95], v11 offset:33280
ds_read_b128 v[96:99], v11 offset:33344
s_waitcnt lgkmcnt(15)
v_mfma_f32_16x16x32_bf16 v[100:103], v[164:167], v[36:39], v[100:103]
v_mfma_f32_16x16x32_bf16 v[104:107], v[168:171], v[36:39], v[104:107]
s_waitcnt lgkmcnt(14)
v_mfma_f32_16x16x32_bf16 v[100:103], v[172:175], v[40:43], v[100:103]
v_mfma_f32_16x16x32_bf16 v[104:107], v[176:179], v[40:43], v[104:107]
s_waitcnt lgkmcnt(13)
v_mfma_f32_16x16x32_bf16 v[100:103], v[180:183], v[44:47], v[100:103]
v_mfma_f32_16x16x32_bf16 v[104:107], v[184:187], v[44:47], v[104:107]
s_waitcnt lgkmcnt(12)
v_mfma_f32_16x16x32_bf16 v[100:103], v[188:191], v[48:51], v[100:103]
v_mfma_f32_16x16x32_bf16 v[104:107], v[192:195], v[48:51], v[104:107]
s_waitcnt lgkmcnt(11)
v_mfma_f32_16x16x32_bf16 v[100:103], v[196:199], v[52:55], v[100:103]
v_mfma_f32_16x16x32_bf16 v[104:107], v[200:203], v[52:55], v[104:107]
s_waitcnt lgkmcnt(10)
v_mfma_f32_16x16x32_bf16 v[100:103], v[204:207], v[56:59], v[100:103]
v_mfma_f32_16x16x32_bf16 v[104:107], v[208:211], v[56:59], v[104:107]
s_waitcnt lgkmcnt(9)
v_mfma_f32_16x16x32_bf16 v[100:103], v[196:199], v[60:63], v[100:103]
v_mfma_f32_16x16x32_bf16 v[104:107], v[200:203], v[60:63], v[104:107]
s_waitcnt lgkmcnt(8)
v_mfma_f32_16x16x32_bf16 v[100:103], v[204:207], v[64:67], v[100:103]
v_mfma_f32_16x16x32_bf16 v[104:107], v[208:211], v[64:67], v[104:107]
ds_read_b128 v[36:39], v16 offset:0
ds_read_b128 v[40:43], v16 offset:64
ds_read_b128 v[44:47], v17 offset:0
ds_read_b128 v[48:51], v17 offset:64
ds_read_b128 v[52:55], v18 offset:0
ds_read_b128 v[56:59], v18 offset:64
ds_read_b128 v[60:63], v19 offset:0
ds_read_b128 v[64:67], v19 offset:64
s_waitcnt lgkmcnt(8)
v_mfma_f32_16x16x32_bf16 v[108:111], v[164:167], v[68:71], v[108:111]
s_nop 6
v_mul_f32 v132, s61, v100
v_mul_f32 v133, s61, v101
v_mfma_f32_16x16x32_bf16 v[112:115], v[168:171], v[68:71], v[112:115]
v_mul_f32 v134, s61, v102
v_mul_f32 v135, s61, v103
v_mfma_f32_16x16x32_bf16 v[108:111], v[172:175], v[72:75], v[108:111]
v_mul_f32 v136, s61, v104
v_mul_f32 v137, s61, v105
v_mfma_f32_16x16x32_bf16 v[112:115], v[176:179], v[72:75], v[112:115]
v_mul_f32 v138, s61, v106
v_mul_f32 v139, s61, v107
v_mfma_f32_16x16x32_bf16 v[108:111], v[180:183], v[76:79], v[108:111]
v_exp_f32 v132, v132
v_exp_f32 v133, v133
v_mfma_f32_16x16x32_bf16 v[112:115], v[184:187], v[76:79], v[112:115]
v_exp_f32 v134, v134
v_exp_f32 v135, v135
v_mfma_f32_16x16x32_bf16 v[108:111], v[188:191], v[80:83], v[108:111]
v_exp_f32 v136, v136
v_exp_f32 v137, v137
v_mfma_f32_16x16x32_bf16 v[112:115], v[192:195], v[80:83], v[112:115]
v_exp_f32 v138, v138
v_exp_f32 v139, v139
v_mfma_f32_16x16x32_bf16 v[108:111], v[196:199], v[84:87], v[108:111]
v_add_f32 v132, 1.0, v132
v_add_f32 v133, 1.0, v133
v_mfma_f32_16x16x32_bf16 v[112:115], v[200:203], v[84:87], v[112:115]
v_add_f32 v134, 1.0, v134
v_add_f32 v135, 1.0, v135
v_mfma_f32_16x16x32_bf16 v[108:111], v[204:207], v[88:91], v[108:111]
v_add_f32 v136, 1.0, v136
v_add_f32 v137, 1.0, v137
v_mfma_f32_16x16x32_bf16 v[112:115], v[208:211], v[88:91], v[112:115]
v_add_f32 v138, 1.0, v138
v_add_f32 v139, 1.0, v139
v_mfma_f32_16x16x32_bf16 v[108:111], v[196:199], v[92:95], v[108:111]
v_rcp_f32 v132, v132
v_rcp_f32 v133, v133
v_mfma_f32_16x16x32_bf16 v[112:115], v[200:203], v[92:95], v[112:115]
v_rcp_f32 v134, v134
v_rcp_f32 v135, v135
v_mfma_f32_16x16x32_bf16 v[108:111], v[204:207], v[96:99], v[108:111]
v_rcp_f32 v136, v136
v_rcp_f32 v137, v137
v_mfma_f32_16x16x32_bf16 v[112:115], v[208:211], v[96:99], v[112:115]
v_rcp_f32 v138, v138
v_rcp_f32 v139, v139
s_nop 0
ds_write_b128 v20, v[132:135] offset:0
ds_write_b128 v20, v[136:139] offset:16
s_waitcnt lgkmcnt(2)
v_mfma_f32_16x16x32_bf16 v[116:119], v[164:167], v[36:39], v[116:119]
s_nop 6
v_mul_f32 v140, s61, v108
v_mul_f32 v141, s61, v109
v_mfma_f32_16x16x32_bf16 v[120:123], v[168:171], v[36:39], v[120:123]
v_mul_f32 v142, s61, v110
v_mul_f32 v143, s61, v111
v_mfma_f32_16x16x32_bf16 v[116:119], v[172:175], v[40:43], v[116:119]
v_mul_f32 v144, s61, v112
v_mul_f32 v145, s61, v113
v_mfma_f32_16x16x32_bf16 v[120:123], v[176:179], v[40:43], v[120:123]
v_mul_f32 v146, s61, v114
v_mul_f32 v147, s61, v115
v_mfma_f32_16x16x32_bf16 v[116:119], v[180:183], v[44:47], v[116:119]
v_exp_f32 v140, v140
v_exp_f32 v141, v141
v_mfma_f32_16x16x32_bf16 v[120:123], v[184:187], v[44:47], v[120:123]
v_exp_f32 v142, v142
v_exp_f32 v143, v143
v_mfma_f32_16x16x32_bf16 v[116:119], v[188:191], v[48:51], v[116:119]
v_exp_f32 v144, v144
v_exp_f32 v145, v145
v_mfma_f32_16x16x32_bf16 v[120:123], v[192:195], v[48:51], v[120:123]
v_exp_f32 v146, v146
v_exp_f32 v147, v147
v_mfma_f32_16x16x32_bf16 v[116:119], v[196:199], v[52:55], v[116:119]
v_add_f32 v140, 1.0, v140
v_add_f32 v141, 1.0, v141
v_mfma_f32_16x16x32_bf16 v[120:123], v[200:203], v[52:55], v[120:123]
v_add_f32 v142, 1.0, v142
v_add_f32 v143, 1.0, v143
v_mfma_f32_16x16x32_bf16 v[116:119], v[204:207], v[56:59], v[116:119]
v_add_f32 v144, 1.0, v144
v_add_f32 v145, 1.0, v145
v_mfma_f32_16x16x32_bf16 v[120:123], v[208:211], v[56:59], v[120:123]
v_add_f32 v146, 1.0, v146
v_add_f32 v147, 1.0, v147
v_mfma_f32_16x16x32_bf16 v[116:119], v[196:199], v[60:63], v[116:119]
v_rcp_f32 v140, v140
v_rcp_f32 v141, v141
v_mfma_f32_16x16x32_bf16 v[120:123], v[200:203], v[60:63], v[120:123]
v_rcp_f32 v142, v142
v_rcp_f32 v143, v143
v_mfma_f32_16x16x32_bf16 v[116:119], v[204:207], v[64:67], v[116:119]
v_rcp_f32 v144, v144
v_rcp_f32 v145, v145
v_mfma_f32_16x16x32_bf16 v[120:123], v[208:211], v[64:67], v[120:123]
v_rcp_f32 v146, v146
v_rcp_f32 v147, v147
s_nop 0
ds_write_b128 v20, v[140:143] offset:4352
ds_write_b128 v20, v[144:147] offset:4368
s_nop 7
v_mul_f32 v148, s61, v116
v_mul_f32 v149, s61, v117
v_mul_f32 v150, s61, v118
v_mul_f32 v151, s61, v119
v_mul_f32 v152, s61, v120
v_mul_f32 v153, s61, v121
v_mul_f32 v154, s61, v122
v_mul_f32 v155, s61, v123
v_exp_f32 v148, v148
v_exp_f32 v149, v149
v_exp_f32 v150, v150
v_exp_f32 v151, v151
v_exp_f32 v152, v152
v_exp_f32 v153, v153
v_exp_f32 v154, v154
v_exp_f32 v155, v155
v_add_f32 v148, 1.0, v148
v_add_f32 v149, 1.0, v149
v_add_f32 v150, 1.0, v150
v_add_f32 v151, 1.0, v151
v_add_f32 v152, 1.0, v152
v_add_f32 v153, 1.0, v153
v_add_f32 v154, 1.0, v154
v_add_f32 v155, 1.0, v155
v_rcp_f32 v148, v148
v_rcp_f32 v149, v149
v_rcp_f32 v150, v150
v_rcp_f32 v151, v151
v_rcp_f32 v152, v152
v_rcp_f32 v153, v153
v_rcp_f32 v154, v154
v_rcp_f32 v155, v155
s_nop 0
ds_write_b128 v20, v[148:151] offset:8704
ds_write_b128 v20, v[152:155] offset:8720
s_waitcnt lgkmcnt(0)
s_barrier
s_branch main_kernel_og0done_25
main_kernel_plain_24:
ds_read_b128 v[36:39], v8 offset:0
ds_read_b128 v[40:43], v8 offset:64
ds_read_b128 v[44:47], v9 offset:0
ds_read_b128 v[48:51], v9 offset:64
ds_read_b128 v[52:55], v10 offset:0
ds_read_b128 v[56:59], v10 offset:64
ds_read_b128 v[60:63], v11 offset:0
ds_read_b128 v[64:67], v11 offset:64
ds_read_b128 v[68:71], v8 offset:33280
ds_read_b128 v[72:75], v8 offset:33344
ds_read_b128 v[76:79], v9 offset:33280
ds_read_b128 v[80:83], v9 offset:33344
ds_read_b128 v[84:87], v10 offset:33280
ds_read_b128 v[88:91], v10 offset:33344
ds_read_b128 v[92:95], v11 offset:33280
ds_read_b128 v[96:99], v11 offset:33344
s_waitcnt lgkmcnt(15)
v_mfma_f32_16x16x32_bf16 v[100:103], v[164:167], v[36:39], v[100:103]
v_mfma_f32_16x16x32_bf16 v[104:107], v[168:171], v[36:39], v[104:107]
s_waitcnt lgkmcnt(14)
v_mfma_f32_16x16x32_bf16 v[100:103], v[172:175], v[40:43], v[100:103]
v_mfma_f32_16x16x32_bf16 v[104:107], v[176:179], v[40:43], v[104:107]
s_waitcnt lgkmcnt(13)
v_mfma_f32_16x16x32_bf16 v[100:103], v[180:183], v[44:47], v[100:103]
v_mfma_f32_16x16x32_bf16 v[104:107], v[184:187], v[44:47], v[104:107]
s_waitcnt lgkmcnt(12)
v_mfma_f32_16x16x32_bf16 v[100:103], v[188:191], v[48:51], v[100:103]
v_mfma_f32_16x16x32_bf16 v[104:107], v[192:195], v[48:51], v[104:107]
s_waitcnt lgkmcnt(11)
v_mfma_f32_16x16x32_bf16 v[100:103], v[196:199], v[52:55], v[100:103]
v_mfma_f32_16x16x32_bf16 v[104:107], v[200:203], v[52:55], v[104:107]
s_waitcnt lgkmcnt(10)
v_mfma_f32_16x16x32_bf16 v[100:103], v[204:207], v[56:59], v[100:103]
v_mfma_f32_16x16x32_bf16 v[104:107], v[208:211], v[56:59], v[104:107]
s_waitcnt lgkmcnt(9)
v_mfma_f32_16x16x32_bf16 v[100:103], v[196:199], v[60:63], v[100:103]
v_mfma_f32_16x16x32_bf16 v[104:107], v[200:203], v[60:63], v[104:107]
s_waitcnt lgkmcnt(8)
v_mfma_f32_16x16x32_bf16 v[100:103], v[204:207], v[64:67], v[100:103]
v_mfma_f32_16x16x32_bf16 v[104:107], v[208:211], v[64:67], v[104:107]
ds_read_b128 v[36:39], v16 offset:0
ds_read_b128 v[40:43], v16 offset:64
ds_read_b128 v[44:47], v17 offset:0
ds_read_b128 v[48:51], v17 offset:64
ds_read_b128 v[52:55], v18 offset:0
ds_read_b128 v[56:59], v18 offset:64
ds_read_b128 v[60:63], v19 offset:0
ds_read_b128 v[64:67], v19 offset:64
s_waitcnt lgkmcnt(8)
v_mfma_f32_16x16x32_bf16 v[108:111], v[164:167], v[68:71], v[108:111]
v_mfma_f32_16x16x32_bf16 v[112:115], v[168:171], v[68:71], v[112:115]
v_mfma_f32_16x16x32_bf16 v[108:111], v[172:175], v[72:75], v[108:111]
v_mfma_f32_16x16x32_bf16 v[112:115], v[176:179], v[72:75], v[112:115]
v_mfma_f32_16x16x32_bf16 v[108:111], v[180:183], v[76:79], v[108:111]
v_mfma_f32_16x16x32_bf16 v[112:115], v[184:187], v[76:79], v[112:115]
v_mfma_f32_16x16x32_bf16 v[108:111], v[188:191], v[80:83], v[108:111]
v_mfma_f32_16x16x32_bf16 v[112:115], v[192:195], v[80:83], v[112:115]
v_mfma_f32_16x16x32_bf16 v[108:111], v[196:199], v[84:87], v[108:111]
v_mfma_f32_16x16x32_bf16 v[112:115], v[200:203], v[84:87], v[112:115]
v_mfma_f32_16x16x32_bf16 v[108:111], v[204:207], v[88:91], v[108:111]
v_mfma_f32_16x16x32_bf16 v[112:115], v[208:211], v[88:91], v[112:115]
v_mfma_f32_16x16x32_bf16 v[108:111], v[196:199], v[92:95], v[108:111]
v_mfma_f32_16x16x32_bf16 v[112:115], v[200:203], v[92:95], v[112:115]
v_mfma_f32_16x16x32_bf16 v[108:111], v[204:207], v[96:99], v[108:111]
v_mfma_f32_16x16x32_bf16 v[112:115], v[208:211], v[96:99], v[112:115]
s_waitcnt lgkmcnt(0)
v_mfma_f32_16x16x32_bf16 v[116:119], v[164:167], v[36:39], v[116:119]
v_mfma_f32_16x16x32_bf16 v[120:123], v[168:171], v[36:39], v[120:123]
v_mfma_f32_16x16x32_bf16 v[116:119], v[172:175], v[40:43], v[116:119]
v_mfma_f32_16x16x32_bf16 v[120:123], v[176:179], v[40:43], v[120:123]
v_mfma_f32_16x16x32_bf16 v[116:119], v[180:183], v[44:47], v[116:119]
v_mfma_f32_16x16x32_bf16 v[120:123], v[184:187], v[44:47], v[120:123]
v_mfma_f32_16x16x32_bf16 v[116:119], v[188:191], v[48:51], v[116:119]
v_mfma_f32_16x16x32_bf16 v[120:123], v[192:195], v[48:51], v[120:123]
v_mfma_f32_16x16x32_bf16 v[116:119], v[196:199], v[52:55], v[116:119]
v_mfma_f32_16x16x32_bf16 v[120:123], v[200:203], v[52:55], v[120:123]
v_mfma_f32_16x16x32_bf16 v[116:119], v[204:207], v[56:59], v[116:119]
v_mfma_f32_16x16x32_bf16 v[120:123], v[208:211], v[56:59], v[120:123]
v_mfma_f32_16x16x32_bf16 v[116:119], v[196:199], v[60:63], v[116:119]
v_mfma_f32_16x16x32_bf16 v[120:123], v[200:203], v[60:63], v[120:123]
v_mfma_f32_16x16x32_bf16 v[116:119], v[204:207], v[64:67], v[116:119]
v_mfma_f32_16x16x32_bf16 v[120:123], v[208:211], v[64:67], v[120:123]
s_cmp_eq_u32 s92, 0
s_cbranch_scc1 main_kernel_fin
s_add_u32 s93, s93, 1
s_cmp_ge_u32 s93, 256
s_cbranch_scc1 main_kernel_fin
s_nop 7
buffer_store_dwordx4 v[100:103], v13, s[20:23], s58 offen offset:0 sc1
buffer_store_dwordx4 v[104:107], v13, s[20:23], s58 offen offset:16 sc1
buffer_store_dwordx4 v[108:111], v13, s[20:23], s58 offen offset:32 sc1
buffer_store_dwordx4 v[112:115], v13, s[20:23], s58 offen offset:48 sc1
buffer_store_dwordx4 v[116:119], v13, s[20:23], s58 offen offset:64 sc1
buffer_store_dwordx4 v[120:123], v13, s[20:23], s58 offen offset:80 sc1
s_branch main_kernel_nextround
main_kernel_slow:
v_and_b32 v8, 63, v0
v_lshrrev_b32 v9, 3, v8
v_bfe_u32 v10, v8, 1, 2
v_bfe_u32 v11, v8, 4, 1
v_xor_b32 v10, v10, v11
v_lshlrev_b32 v9, 7, v9
v_lshl_add_u32 v9, v10, 5, v9
v_and_b32 v10, 1, v8
v_lshl_add_u32 v9, v10, 4, v9
v_xor_b32 v10, 64, v9
s_lshl_b32 s87, s3, 11
s_add_u32 s88, s87, 52992
s_mov_b32 m0, s88
s_add_u32 s89, s87, 1024
buffer_load_dwordx4 v9, s[28:31], s87 offen lds
s_add_u32 s88, s88, 1024
s_mov_b32 m0, s88
s_nop 0
buffer_load_dwordx4 v10, s[28:31], s89 offen lds
s_mul_i32 s87, s3, 3072
s_add_u32 s89, s3, 0
s_and_b32 s89, s89, 1
s_lshl_b32 s89, s89, 6
v_xor_b32 v11, s89, v9
s_add_u32 s89, s87, 0
s_add_u32 s88, s89, 69376
s_mov_b32 m0, s88
s_nop 0
buffer_load_dwordx4 v11, s[32:35], s89 offen lds
s_add_u32 s89, s3, 1
s_and_b32 s89, s89, 1
s_lshl_b32 s89, s89, 6
v_xor_b32 v11, s89, v9
s_add_u32 s89, s87, 1024
s_add_u32 s88, s89, 69376
s_mov_b32 m0, s88
s_nop 0
buffer_load_dwordx4 v11, s[32:35], s89 offen lds
s_add_u32 s89, s3, 2
s_and_b32 s89, s89, 1
s_lshl_b32 s89, s89, 6
v_xor_b32 v11, s89, v9
s_add_u32 s89, s87, 2048
s_add_u32 s88, s89, 69376
s_mov_b32 m0, s88
s_nop 0
buffer_load_dwordx4 v11, s[32:35], s89 offen lds
s_mul_hi_u32 s87, s3, 0x55555556
s_mul_i32 s87, s87, 3
s_sub_u32 s87, s3, s87
s_lshl_b32 s87, s87, 10
s_add_u32 s88, s87, 2816
s_mov_b32 m0, s88
v_lshlrev_b32 v11, 4, v8
buffer_load_dwordx4 v11, s[24:27], s87 offen lds
s_waitcnt vmcnt(0) lgkmcnt(0)
s_barrier
v_bfe_u32 v228, v0, 4, 2
v_bfe_u32 v229, v0, 2, 2
v_and_b32 v230, 3, v0
v_lshrrev_b32 v232, 1, v229
v_and_b32 v233, 1, v228
v_lshl_add_u32 v232, v233, 1, v232
s_and_b32 s84, s3, 1
s_lshl_b32 s84, s84, 1
v_lshrrev_b32 v233, 1, v230
v_add_u32 v233, s84, v233
v_xor_b32 v232, v233, v232
v_lshlrev_b32 v231, 3, v228
v_add_u32 v231, v231, v229
v_lshlrev_b32 v231, 7, v231
v_lshl_add_u32 v231, v232, 5, v231
v_and_b32 v233, 1, v230
v_lshl_add_u32 v231, v233, 4, v231
v_add_u32 v4, 52992, v231
s_cmp_lg_u32 s92, 0
s_cbranch_scc1 main_kernel_s_nf2
s_cmp_lt_u32 s3, 2
s_mov_b32 s85, 16384
s_cselect_b32 s85, 0, s85
v_add_u32 v7, s85, v4
ds_read_b64_tr_b16 v[164:165], v7 offset:0
ds_read_b64_tr_b16 v[166:167], v7 offset:512
ds_read_b64_tr_b16 v[168:169], v7 offset:8
ds_read_b64_tr_b16 v[170:171], v7 offset:520
ds_read_b64_tr_b16 v[172:173], v7 offset:4096
ds_read_b64_tr_b16 v[174:175], v7 offset:4608
ds_read_b64_tr_b16 v[176:177], v7 offset:4104
ds_read_b64_tr_b16 v[178:179], v7 offset:4616
s_mov_b32 s85, 24576
s_cselect_b32 s85, 8192, s85
v_add_u32 v7, s85, v4
ds_read_b64_tr_b16 v[180:181], v7 offset:0
ds_read_b64_tr_b16 v[182:183], v7 offset:512
ds_read_b64_tr_b16 v[184:185], v7 offset:8
ds_read_b64_tr_b16 v[186:187], v7 offset:520
ds_read_b64_tr_b16 v[188:189], v7 offset:4096
ds_read_b64_tr_b16 v[190:191], v7 offset:4608
ds_read_b64_tr_b16 v[192:193], v7 offset:4104
ds_read_b64_tr_b16 v[194:195], v7 offset:4616
s_mov_b32 s85, 32768
s_cselect_b32 s85, 8192, s85
v_add_u32 v7, s85, v4
ds_read_b64_tr_b16 v[196:197], v7 offset:0
ds_read_b64_tr_b16 v[198:199], v7 offset:512
ds_read_b64_tr_b16 v[200:201], v7 offset:8
ds_read_b64_tr_b16 v[202:203], v7 offset:520
ds_read_b64_tr_b16 v[204:205], v7 offset:4096
ds_read_b64_tr_b16 v[206:207], v7 offset:4608
ds_read_b64_tr_b16 v[208:209], v7 offset:4104
ds_read_b64_tr_b16 v[210:211], v7 offset:4616
v_mov_b32 v7, 264
v_mov_b32 v4, 1
s_mov_b64 exec, 1
ds_add_u32 v7, v4
s_mov_b64 exec, -1
main_kernel_s_nf2:
s_waitcnt lgkmcnt(0)
s_barrier
s_mov_b32 s92, 1
s_mov_b32 s93, 0
main_kernel_nextround:
s_waitcnt vmcnt(0) lgkmcnt(0)
s_barrier
v_lshlrev_b32 v1, 2, v0
v_mov_b32 v2, 0
v_cmp_gt_u32 vcc, 80, v0
s_and_b64 exec, exec, vcc
ds_write_b32 v1, v2 offset:0
s_mov_b64 exec, -1
s_lshl_b32 s84, s93, 10
s_lshl_b32 s85, s95, 2
s_add_u32 s84, s84, s85
s_add_u32 s84, s84, 10880000
v_mov_b32 v1, 0
buffer_load_dword v1, v1, s[20:23], s84 offen
s_waitcnt vmcnt(0) lgkmcnt(0)
v_lshrrev_b32 v2, 20, v1
v_and_b32 v1, 0xfffff, v1
v_subrev_u32 v3, 0, v2
v_max_i32 v3, 0, v3
v_min_u32 v3, 512, v3
v_add_u32 v4, 0, v1
v_lshl_or_b32 v92, v3, 20, v4
v_subrev_u32 v3, 512, v2
v_max_i32 v3, 0, v3
v_min_u32 v3, 512, v3
v_add_u32 v4, 512, v1
v_lshl_or_b32 v93, v3, 20, v4
v_subrev_u32 v3, 1024, v2
v_max_i32 v3, 0, v3
v_min_u32 v3, 512, v3
v_add_u32 v4, 1024, v1
v_lshl_or_b32 v94, v3, 20, v4
v_subrev_u32 v3, 1536, v2
v_max_i32 v3, 0, v3
v_min_u32 v3, 512, v3
v_add_u32 v4, 1536, v1
v_lshl_or_b32 v95, v3, 20, v4
v_subrev_u32 v3, 2048, v2
v_max_i32 v3, 0, v3
v_min_u32 v3, 512, v3
v_add_u32 v4, 2048, v1
v_lshl_or_b32 v96, v3, 20, v4
v_subrev_u32 v3, 2560, v2
v_max_i32 v3, 0, v3
v_min_u32 v3, 512, v3
v_add_u32 v4, 2560, v1
v_lshl_or_b32 v97, v3, 20, v4
v_subrev_u32 v3, 3072, v2
v_max_i32 v3, 0, v3
v_min_u32 v3, 512, v3
v_add_u32 v4, 3072, v1
v_lshl_or_b32 v98, v3, 20, v4
v_subrev_u32 v3, 3584, v2
v_max_i32 v3, 0, v3
v_min_u32 v3, 512, v3
v_add_u32 v4, 3584, v1
v_lshl_or_b32 v99, v3, 20, v4
v_mov_b32 v91, v0
s_barrier
s_branch main_kernel_round
main_kernel_fin:
s_barrier
ds_read_b128 v[36:39], v20 offset:0
ds_read_b128 v[40:43], v20 offset:16
ds_read_b128 v[44:47], v20 offset:4352
ds_read_b128 v[48:51], v20 offset:4368
ds_read_b128 v[52:55], v20 offset:8704
ds_read_b128 v[56:59], v20 offset:8720
s_waitcnt lgkmcnt(5)
v_mul_f32 v100, v100, v36
v_mul_f32 v101, v101, v37
v_mul_f32 v102, v102, v38
v_mul_f32 v103, v103, v39
s_waitcnt lgkmcnt(4)
v_mul_f32 v104, v104, v40
v_mul_f32 v105, v105, v41
v_mul_f32 v106, v106, v42
v_mul_f32 v107, v107, v43
s_waitcnt lgkmcnt(3)
v_mul_f32 v108, v108, v44
v_mul_f32 v109, v109, v45
v_mul_f32 v110, v110, v46
v_mul_f32 v111, v111, v47
s_waitcnt lgkmcnt(2)
v_mul_f32 v112, v112, v48
v_mul_f32 v113, v113, v49
v_mul_f32 v114, v114, v50
v_mul_f32 v115, v115, v51
s_waitcnt lgkmcnt(1)
v_mul_f32 v116, v116, v52
v_mul_f32 v117, v117, v53
v_mul_f32 v118, v118, v54
v_mul_f32 v119, v119, v55
s_waitcnt lgkmcnt(0)
v_mul_f32 v120, v120, v56
v_mul_f32 v121, v121, v57
v_mul_f32 v122, v122, v58
v_mul_f32 v123, v123, v59
main_kernel_og0done_25:
v_cmp_gt_u32 vcc, s57, v2
v_cvt_pk_bf16_f32 v68, v100, v101
v_cvt_pk_bf16_f32 v69, v102, v103
v_cvt_pk_bf16_f32 v70, v104, v105
v_cvt_pk_bf16_f32 v71, v106, v107
buffer_store_dwordx4 v[68:71], v21, s[36:39], s56 offen sc1
v_cvt_pk_bf16_f32 v72, v108, v109
v_cvt_pk_bf16_f32 v73, v110, v111
v_cvt_pk_bf16_f32 v74, v112, v113
v_cvt_pk_bf16_f32 v75, v114, v115
buffer_store_dwordx4 v[72:75], v22, s[36:39], s56 offen sc1
v_cvt_pk_bf16_f32 v76, v116, v117
v_cvt_pk_bf16_f32 v77, v118, v119
v_cvt_pk_bf16_f32 v78, v120, v121
v_cvt_pk_bf16_f32 v79, v122, v123
s_and_b64 exec, exec, vcc
buffer_store_dwordx4 v[76:79], v23, s[36:39], s56 offen sc1
main_kernel_done:
s_endpgm
.section .rodata,"a"
.p2align 6
.amdhsa_kernel main_kernel
  .amdhsa_next_free_vgpr 256
  .amdhsa_next_free_sgpr 102
  .amdhsa_accum_offset 256
  .amdhsa_group_segment_fixed_size 0
  .amdhsa_kernarg_size 96
  .amdhsa_user_sgpr_count 2
  .amdhsa_user_sgpr_kernarg_segment_ptr 1
  .amdhsa_system_sgpr_workgroup_id_x 1
.end_amdhsa_kernel
.text
```
